```python
import torch

def _softmax(x, axis=-1):
    return torch.softmax(x, dim=axis)
def _gelu(x):
    return torch.nn.functional.gelu(x, approximate="tanh")
def _silu(x):
    return torch.nn.functional.silu(x)
def _sigmoid(x):
    return torch.sigmoid(x)
def _layernorm(x, axis=-1, eps=1e-5):
    m = x.mean(dim=axis, keepdim=True)
    v = x.var(dim=axis, keepdim=True, unbiased=False)
    return (x - m) / torch.sqrt(v + eps)
def _scatter_add(tgt, idx, src, axis=0):
    return tgt.clone().index_add_(axis, idx, src)
def _segment_sum(src, seg, n):
    out = torch.zeros((n,) + src.shape[1:], dtype=src.dtype)
    return out.index_add_(0, seg, src)
def _pad(x, pw):
    flat = tuple(v for pair in reversed(pw) for v in pair)
    return torch.nn.functional.pad(x, flat)

kernel_name = 'gated_mix__gqa_block_cached__glu_gated_glu__decode'

def setup_inputs():

    _w = (lambda a: (lambda t: t.to(torch.bfloat16) if t.is_floating_point() else t)(torch.as_tensor(a)))
    def _A_setup():
        B, Sq, D = 8, 1, 512
        Hq, Hkv, Sk, Dh = 32, 8, 8192, 128
        assert Hq % Hkv == 0, (Hq, Hkv)
        return {
            "x": _w((lambda *s: torch.randn(*s, dtype=torch.bfloat16) * 0.05)(B, Sq, D)),
            "k_cache": _w((lambda *s: torch.randn(*s, dtype=torch.bfloat16) * 6.4)(B, Hkv, Sk, Dh)),
            "v_cache": _w((lambda *s: torch.randn(*s, dtype=torch.bfloat16) * 0.4)(B, Hkv, Sk, Dh)),
            "wq": _w((lambda *s: torch.randn(*s, dtype=torch.bfloat16) * 6.4)(D, Hq * Dh) * (D ** -0.5)),
            "wo": _w((lambda *s: torch.randn(*s, dtype=torch.bfloat16) * 0.4)(Hq * Dh, D) * ((Hq * Dh) ** -0.5)),
        }
    _A_in = _A_setup()

    def _B_setup():
        B, S, D, F = 8, 1, 512, 1792
        return {
            "x": _w((lambda *s: torch.randn(*s, dtype=torch.bfloat16) * 0.05)(B, S, D)),
            "w_gate": _w((lambda *s: torch.randn(*s, dtype=torch.bfloat16) * 0.4)(D, F)),
            "w_up": _w((lambda *s: torch.randn(*s, dtype=torch.bfloat16) * 0.05)(D, F)),
            "w_down": _w((lambda *s: torch.randn(*s, dtype=torch.bfloat16) * 0.05)(F, D)),
        }
    _B_in = _B_setup()

    return {
        "A_x": _A_in["x"],
        "A_k_cache": _A_in["k_cache"],
        "A_v_cache": _A_in["v_cache"],
        "A_wq": _A_in["wq"],
        "A_wo": _A_in["wo"],
        "B_x": _B_in["x"],
        "B_w_gate": _B_in["w_gate"],
        "B_w_up": _B_in["w_up"],
        "B_w_down": _B_in["w_down"],
        "gate_w": _w((lambda *s: torch.randn(*s, dtype=torch.bfloat16) * 0.05)(512) * 16.0),
    }

def reference(A_x, A_k_cache, A_v_cache, A_wq, A_wo, B_x, B_w_gate, B_w_up, B_w_down, gate_w):
    def _A_ref(x, k_cache, v_cache, wq, wo):
        B, Sq, D = x.shape
        Hq, Dh = 32, 128
        Hkv = k_cache.shape[1]
        rep = Hq // Hkv
        q = (lambda x, *d: x.permute(*d))((x @ wq).reshape(B, Sq, Hq, Dh), 0, 2, 1, 3)
        k = (lambda x, n, axis: torch.repeat_interleave(x, n, dim=axis))(k_cache, rep, axis=1)
        v = (lambda x, n, axis: torch.repeat_interleave(x, n, dim=axis))(v_cache, rep, axis=1)
        scores = torch.einsum("bhqd,bhkd->bhqk", q, k) * (Dh ** -0.5)
        p = _softmax(scores, axis=-1)
        o = torch.einsum("bhqk,bhkd->bhqd", p, v)
        return (lambda x, *d: x.permute(*d))(o, 0, 2, 1, 3).reshape(B, Sq, Hq * Dh) @ wo

    def _B_ref(x, w_gate, w_up, w_down):
        g = torch.einsum("bsd,df->bsf", x, w_gate)
        u = torch.einsum("bsd,df->bsf", x, w_up)
        h = _sigmoid(g) * u
        return torch.einsum("bsf,fd->bsd", h, w_down)

    x = A_x
    g = _sigmoid((x * gate_w).sum(-1, keepdims=True))
    a = _A_ref(x, A_k_cache, A_v_cache, A_wq, A_wo)
    b = _B_ref(x, B_w_gate, B_w_up, B_w_down)
    return g * a + (1 - g) * b
```

```asm
; @launch grid=(256,1,1) block=(512,1,1) lds=163840
.amdgcn_target "amdgcn-amd-amdhsa--gfx950"
.text
.globl gated_mix__gqa_block_cached__glu_gated_glu__decode_kernel
.p2align 8
.type gated_mix__gqa_block_cached__glu_gated_glu__decode_kernel,@function
gated_mix__gqa_block_cached__glu_gated_glu__decode_kernel:
    s_cmp_ge_u32 s2, 256
    s_cbranch_scc1 L_done
    s_load_dwordx16 s[16:31], s[0:1], 0
    s_load_dwordx8 s[32:39], s[0:1], 64
    s_load_dwordx2 s[40:41], s[0:1], 96
    v_lshrrev_b32 v1, 6, v0
    v_and_b32 v0, 63, v0
    v_readfirstlane_b32 s3, v1
    v_and_b32 v50, 3, v0
    v_bfe_u32 v51, v0, 2, 2
    v_lshrrev_b32 v52, 4, v0
    v_lshrrev_b32 v58, 3, v0
    v_and_b32 v59, 7, v0
    v_lshlrev_b32 v59, 4, v59
    s_and_b32 s89, s2, 7
    s_lshr_b32 s90, s2, 3
    s_lshl_b32 s80, s3, 14
    s_and_b32 s82, s89, 1
    s_bfe_u32 s83, s89, 0x10002
    s_lshl_b32 s83, s83, 1
    s_or_b32 s82, s82, s83
    s_bfe_u32 s83, s89, 0x10001
    s_lshl_b32 s83, s83, 2
    s_or_b32 s82, s82, s83
    s_bitcmp1_b32 s90, 0
    s_cselect_b32 s82, s82, s89
    s_lshl_b32 s79, s90, 3
    s_add_u32 s79, s79, s82
    s_lshr_b32 s81, s79, 2
    s_lshl_b32 s81, s81, 21
    s_add_u32 s78, s81, 0x1c0000
    s_and_b32 s82, s79, 3
    s_mul_i32 s82, s82, 0x70000
    s_add_u32 s81, s81, s82
    s_lshl_b32 s82, s3, 12
    s_add_u32 s81, s81, s82
    s_memrealtime s[74:75]
    s_lshr_b32 s43, s79, 2
    s_bfe_u32 s42, s43, 0x10002
    s_lshr_b32 s82, s43, 3
    s_lshl_b32 s82, s82, 2
    s_and_b32 s83, s43, 3
    s_add_u32 s82, s82, s83
    s_lshl_b32 s82, s82, 1
    s_add_u32 s42, s42, s82
    s_and_b32 s83, s79, 3
    s_cmp_ge_u32 s42, 56
    s_cselect_b32 s82, 2, 1
    s_cmp_eq_u32 s83, 2
    s_cselect_b32 s91, s82, 2
    s_cmp_eq_u32 s83, 0
    s_cselect_b32 s91, 0, s91
    v_lshlrev_b32 v1, 4, v50
    v_lshl_add_u32 v1, v51, 8, v1
    v_lshl_add_u32 v1, v52, 6, v1
    v_and_b32 v53, 15, v0
    v_and_b32 v54, 1, v52
    v_lshlrev_b32 v54, 1, v54
    v_xor_b32 v53, v53, v54
    v_xor_b32 v55, 0, v53
    v_lshlrev_b32 v55, 4, v55
    v_lshl_add_u32 v2, v52, 8, v55
    v_xor_b32 v55, 4, v53
    v_lshlrev_b32 v55, 4, v55
    v_lshl_add_u32 v3, v52, 8, v55
    v_xor_b32 v55, 8, v53
    v_lshlrev_b32 v55, 4, v55
    v_lshl_add_u32 v4, v52, 8, v55
    v_xor_b32 v55, 12, v53
    v_lshlrev_b32 v55, 4, v55
    v_lshl_add_u32 v5, v52, 8, v55
    v_lshl_add_u32 v55, v51, 2, v52
    v_lshlrev_b32 v55, 8, v55
    v_lshl_add_u32 v55, v50, 3, v55
    v_add_u32 v55, s80, v55
    v_and_b32 v56, 1, v52
    v_lshl_add_u32 v56, v51, 1, v56
    v_xor_b32 v57, 0, v56
    v_lshl_add_u32 v6, v57, 5, v55
    v_xor_b32 v57, 1, v56
    v_lshl_add_u32 v7, v57, 5, v55
    v_xor_b32 v57, 2, v56
    v_lshl_add_u32 v8, v57, 5, v55
    v_xor_b32 v57, 3, v56
    v_lshl_add_u32 v9, v57, 5, v55
    v_xor_b32 v57, 4, v56
    v_lshl_add_u32 v10, v57, 5, v55
    v_xor_b32 v57, 5, v56
    v_lshl_add_u32 v11, v57, 5, v55
    v_xor_b32 v57, 6, v56
    v_lshl_add_u32 v12, v57, 5, v55
    v_xor_b32 v57, 7, v56
    v_lshl_add_u32 v13, v57, 5, v55
    v_lshl_add_u32 v62, v52, 3, v51
    v_lshlrev_b32 v62, 7, v62
    v_lshl_add_u32 v62, v50, 3, v62
    v_and_b32 v63, 15, v0
    s_waitcnt lgkmcnt(0)
    s_add_u32 s62, s40, 229376
    s_addc_u32 s63, s41, 0
    s_load_dwordx2 s[70:71], s[62:63], 0
    s_mov_b32 s4, s18
    s_and_b32 s5, s19, 0xffff
    s_mov_b32 s6, 134217728
    s_mov_b32 s7, 0x20000
    s_mov_b32 s8, s20
    s_and_b32 s9, s21, 0xffff
    s_mov_b32 s10, 134217728
    s_mov_b32 s11, 0x20000
    s_mov_b32 s12, s40
    s_and_b32 s13, s41, 0xffff
    s_mov_b32 s14, 2097152
    s_mov_b32 s15, 0x20000
    s_mov_b32 s60, 0x00ff00ff
    s_mov_b32 s61, 0x00ff00ff
    s_lshr_b32 s86, 12, s3
    s_bitcmp1_b32 s86, 0
    s_cselect_b64 vcc, -1, 0
    s_cmp_lt_u32 s3, 4
    s_cbranch_scc1 L_lo
    s_cmp_eq_u32 s91, 0
    s_cbranch_scc1 L_prodq_pre
    s_cmp_eq_u32 s91, 1
    s_cbranch_scc1 L_prodg_pre
    s_mov_b32 s83, s81
    buffer_load_dwordx4 v[64:67], v1, s[4:7], s83 offen offset:0 nt
    buffer_load_dwordx4 v[68:71], v1, s[4:7], s83 offen offset:1024 nt
    buffer_load_dwordx4 v[72:75], v1, s[4:7], s83 offen offset:2048 nt
    buffer_load_dwordx4 v[76:79], v1, s[4:7], s83 offen offset:3072 nt
    s_branch L_bar0
L_lo:
    s_mov_b32 s83, s81
    buffer_load_dwordx4 v[64:67], v1, s[4:7], s83 offen offset:0 nt
    buffer_load_dwordx4 v[68:71], v1, s[4:7], s83 offen offset:1024 nt
    buffer_load_dwordx4 v[72:75], v1, s[4:7], s83 offen offset:2048 nt
    buffer_load_dwordx4 v[76:79], v1, s[4:7], s83 offen offset:3072 nt
    s_cmp_lg_u32 s3, 0
    s_cbranch_scc1 L_bar0
    v_mov_b32 v60, 147456
    s_cmp_eq_u32 s91, 2
    s_cselect_b32 s86, 1, 0
    v_mov_b32 v56, s86
    v_mov_b32 v57, 0
    ds_write_b64 v60, v[56:57]
    ds_write_b32 v60, v57 offset:8
    ds_write_b32 v60, v57 offset:12
    ds_write_b32 v60, v57 offset:32
L_bar0:
    s_waitcnt lgkmcnt(0)
    s_add_u32 s70, s70, 1
    s_add_u32 s71, s71, 0x9e3779b9
    s_barrier
    s_cmp_eq_u32 s3, 0
    s_cbranch_scc1 L_role0
    s_cmp_eq_u32 s3, 1
    s_cbranch_scc1 L_stream_4
    s_cmp_eq_u32 s3, 2
    s_cbranch_scc1 L_role2
    s_cmp_eq_u32 s3, 3
    s_cbranch_scc1 L_role3
    s_cmp_lt_u32 s91, 2
    s_cbranch_scc1 L_prod
    s_branch L_stream_4
L_stream_0:
    s_waitcnt vmcnt(3)
    s_add_u32 s83, s81, 0
    buffer_load_dwordx4 v[64:67], v1, s[4:7], s83 offen offset:0 nt
    s_waitcnt vmcnt(3)
    buffer_load_dwordx4 v[68:71], v1, s[4:7], s83 offen offset:1024 nt
    s_waitcnt vmcnt(3)
    buffer_load_dwordx4 v[72:75], v1, s[4:7], s83 offen offset:2048 nt
    s_waitcnt vmcnt(3)
    buffer_load_dwordx4 v[76:79], v1, s[4:7], s83 offen offset:3072 nt
L_stream_4:
    s_waitcnt vmcnt(3)
    s_add_u32 s83, s81, 32768
    buffer_load_dwordx4 v[80:83], v1, s[4:7], s83 offen offset:0 nt
    s_waitcnt vmcnt(3)
    buffer_load_dwordx4 v[84:87], v1, s[4:7], s83 offen offset:1024 nt
    s_waitcnt vmcnt(3)
    buffer_load_dwordx4 v[88:91], v1, s[4:7], s83 offen offset:2048 nt
    s_waitcnt vmcnt(3)
    buffer_load_dwordx4 v[92:95], v1, s[4:7], s83 offen offset:3072 nt
L_stream_8:
    s_waitcnt vmcnt(3)
    s_add_u32 s83, s81, 65536
    buffer_load_dwordx4 v[96:99], v1, s[4:7], s83 offen offset:0 nt
    s_waitcnt vmcnt(3)
    buffer_load_dwordx4 v[100:103], v1, s[4:7], s83 offen offset:1024 nt
    s_waitcnt vmcnt(3)
    buffer_load_dwordx4 v[104:107], v1, s[4:7], s83 offen offset:2048 nt
    s_waitcnt vmcnt(3)
    buffer_load_dwordx4 v[108:111], v1, s[4:7], s83 offen offset:3072 nt
L_stream_12:
    s_waitcnt vmcnt(3)
    s_add_u32 s83, s81, 98304
    buffer_load_dwordx4 v[112:115], v1, s[4:7], s83 offen offset:0 nt
    s_waitcnt vmcnt(3)
    buffer_load_dwordx4 v[116:119], v1, s[4:7], s83 offen offset:1024 nt
    s_waitcnt vmcnt(3)
    buffer_load_dwordx4 v[120:123], v1, s[4:7], s83 offen offset:2048 nt
    s_waitcnt vmcnt(3)
    buffer_load_dwordx4 v[124:127], v1, s[4:7], s83 offen offset:3072 nt
L_stream_16:
    s_waitcnt vmcnt(3)
    s_add_u32 s83, s81, 131072
    buffer_load_dwordx4 v[128:131], v1, s[4:7], s83 offen offset:0 nt
    s_waitcnt vmcnt(3)
    buffer_load_dwordx4 v[132:135], v1, s[4:7], s83 offen offset:1024 nt
    s_waitcnt vmcnt(3)
    buffer_load_dwordx4 v[136:139], v1, s[4:7], s83 offen offset:2048 nt
    s_waitcnt vmcnt(3)
    buffer_load_dwordx4 v[140:143], v1, s[4:7], s83 offen offset:3072 nt
L_stream_20:
    s_waitcnt vmcnt(3)
    s_add_u32 s83, s81, 163840
    buffer_load_dwordx4 v[144:147], v1, s[4:7], s83 offen offset:0 nt
    s_waitcnt vmcnt(3)
    buffer_load_dwordx4 v[148:151], v1, s[4:7], s83 offen offset:1024 nt
    s_waitcnt vmcnt(3)
    buffer_load_dwordx4 v[152:155], v1, s[4:7], s83 offen offset:2048 nt
    s_waitcnt vmcnt(3)
    buffer_load_dwordx4 v[156:159], v1, s[4:7], s83 offen offset:3072 nt
L_stream_24:
    s_waitcnt vmcnt(3)
    s_add_u32 s83, s81, 196608
    buffer_load_dwordx4 v[160:163], v1, s[4:7], s83 offen offset:0 nt
    s_waitcnt vmcnt(3)
    buffer_load_dwordx4 v[164:167], v1, s[4:7], s83 offen offset:1024 nt
    s_waitcnt vmcnt(3)
    buffer_load_dwordx4 v[168:171], v1, s[4:7], s83 offen offset:2048 nt
    s_waitcnt vmcnt(3)
    buffer_load_dwordx4 v[172:175], v1, s[4:7], s83 offen offset:3072 nt
L_stream_28:
    s_waitcnt vmcnt(3)
    s_add_u32 s83, s81, 229376
    buffer_load_dwordx4 v[176:179], v1, s[4:7], s83 offen offset:0 nt
    s_waitcnt vmcnt(3)
    buffer_load_dwordx4 v[180:183], v1, s[4:7], s83 offen offset:1024 nt
    s_waitcnt vmcnt(3)
    buffer_load_dwordx4 v[184:187], v1, s[4:7], s83 offen offset:2048 nt
    s_waitcnt vmcnt(3)
    buffer_load_dwordx4 v[188:191], v1, s[4:7], s83 offen offset:3072 nt
L_stream_32:
    s_waitcnt vmcnt(3)
    s_add_u32 s83, s81, 262144
    buffer_load_dwordx4 v[192:195], v1, s[4:7], s83 offen offset:0 nt
    s_waitcnt vmcnt(3)
    buffer_load_dwordx4 v[196:199], v1, s[4:7], s83 offen offset:1024 nt
    s_waitcnt vmcnt(3)
    buffer_load_dwordx4 v[200:203], v1, s[4:7], s83 offen offset:2048 nt
    s_waitcnt vmcnt(3)
    buffer_load_dwordx4 v[204:207], v1, s[4:7], s83 offen offset:3072 nt
    s_waitcnt vmcnt(3)
    s_add_u32 s83, s81, 294912
    buffer_load_dwordx4 v[208:211], v1, s[4:7], s83 offen offset:0 nt
    s_waitcnt vmcnt(3)
    buffer_load_dwordx4 v[212:215], v1, s[4:7], s83 offen offset:1024 nt
    s_waitcnt vmcnt(3)
    buffer_load_dwordx4 v[216:219], v1, s[4:7], s83 offen offset:2048 nt
    s_waitcnt vmcnt(3)
    buffer_load_dwordx4 v[220:223], v1, s[4:7], s83 offen offset:3072 nt
    s_cmp_eq_u32 s3, 3
    s_cbranch_scc1 L_gate
L_gate_ret:
    v_mov_b32 v50, 147456
    s_mov_b32 s85, 200000
    v_mov_b32 v42, 0xff7fffff
    v_mov_b32 v43, 0xff7fffff
    v_mov_b32 v44, 0xff7fffff
    v_mov_b32 v45, 0xff7fffff
    v_mov_b32 v46, 0xff7fffff
    v_mov_b32 v47, 0xff7fffff
    v_mov_b32 v48, 0xff7fffff
    v_mov_b32 v49, 0xff7fffff
L_qwait:
    ds_read_b32 v51, v50
    s_waitcnt lgkmcnt(0)
    v_readfirstlane_b32 s86, v51
    s_sub_u32 s85, s85, 1
    s_cmp_eq_u32 s85, 0
    s_cbranch_scc1 L_qok
    s_cmp_ge_u32 s86, 2
    s_cbranch_scc1 L_qok
    s_sleep 2
    s_branch L_qwait
L_qok:
    v_lshlrev_b32 v50, 4, v0
    v_add_u32 v50, 148480, v50
    ds_read_b128 v[14:17], v50
    s_waitcnt lgkmcnt(0)
    s_waitcnt vmcnt(3)
    s_add_u32 s83, s81, 327680
    buffer_load_dwordx4 v[224:227], v1, s[4:7], s83 offen offset:0 nt
    s_waitcnt vmcnt(40)
    v_mfma_f32_16x16x32_bf16 v[18:21], v[64:67], v[14:17], 0
    s_nop 0
    s_nop 0
    s_nop 0
    s_nop 0
    s_waitcnt vmcnt(39)
    v_mfma_f32_16x16x32_bf16 v[22:25], v[68:71], v[14:17], 0
    s_nop 0
    s_nop 0
    s_nop 0
    s_nop 0
    s_waitcnt vmcnt(3)
    buffer_load_dwordx4 v[228:231], v1, s[4:7], s83 offen offset:1024 nt
    s_waitcnt vmcnt(39)
    v_mfma_f32_16x16x32_bf16 v[26:29], v[72:75], v[14:17], 0
    v_mov_b32_dpp v34, v18 quad_perm:[0,1,2,3] row_mask:0xf bank_mask:1
    s_nop 0
    s_nop 0
    s_nop 0
    s_waitcnt vmcnt(38)
    v_mfma_f32_16x16x32_bf16 v[30:33], v[76:79], v[14:17], 0
    v_mov_b32_dpp v35, v22 quad_perm:[0,1,2,3] row_mask:0xf bank_mask:1
    v_add_f32_dpp v34, v19, v34 row_ror:12 row_mask:0xf bank_mask:1
    s_nop 0
    s_nop 0
    s_waitcnt vmcnt(3)
    buffer_load_dwordx4 v[232:235], v1, s[4:7], s83 offen offset:2048 nt
    s_waitcnt vmcnt(38)
    v_mfma_f32_16x16x32_bf16 v[50:53], v[80:83], v[14:17], 0
    v_mov_b32_dpp v36, v26 quad_perm:[0,1,2,3] row_mask:0xf bank_mask:1
    v_add_f32_dpp v35, v23, v35 row_ror:12 row_mask:0xf bank_mask:1
    v_add_f32_dpp v34, v20, v34 row_ror:8 row_mask:0xf bank_mask:1
    s_nop 0
    s_waitcnt vmcnt(37)
    v_mfma_f32_16x16x32_bf16 v[54:57], v[84:87], v[14:17], 0
    v_mov_b32_dpp v37, v30 quad_perm:[0,1,2,3] row_mask:0xf bank_mask:1
    v_add_f32_dpp v36, v27, v36 row_ror:12 row_mask:0xf bank_mask:1
    v_add_f32_dpp v35, v24, v35 row_ror:8 row_mask:0xf bank_mask:1
    v_add_f32_dpp v34, v21, v34 row_ror:4 row_mask:0xf bank_mask:1
    s_waitcnt vmcnt(3)
    buffer_load_dwordx4 v[236:239], v1, s[4:7], s83 offen offset:3072 nt
    s_waitcnt vmcnt(37)
    v_mfma_f32_16x16x32_bf16 v[18:21], v[88:91], v[14:17], 0
    v_mov_b32_dpp v38, v50 quad_perm:[0,1,2,3] row_mask:0xf bank_mask:1
    v_add_f32_dpp v37, v31, v37 row_ror:12 row_mask:0xf bank_mask:1
    v_add_f32_dpp v36, v28, v36 row_ror:8 row_mask:0xf bank_mask:1
    v_add_f32_dpp v35, v25, v35 row_ror:4 row_mask:0xf bank_mask:1
    s_waitcnt vmcnt(36)
    v_mfma_f32_16x16x32_bf16 v[22:25], v[92:95], v[14:17], 0
    v_mov_b32_dpp v39, v54 quad_perm:[0,1,2,3] row_mask:0xf bank_mask:1
    v_add_f32_dpp v38, v51, v38 row_ror:12 row_mask:0xf bank_mask:1
    v_add_f32_dpp v37, v32, v37 row_ror:8 row_mask:0xf bank_mask:1
    v_add_f32_dpp v36, v29, v36 row_ror:4 row_mask:0xf bank_mask:1
    s_waitcnt vmcnt(3)
    s_add_u32 s83, s81, 360448
    buffer_load_dwordx4 v[240:243], v1, s[4:7], s83 offen offset:0 nt
    s_waitcnt vmcnt(36)
    v_mfma_f32_16x16x32_bf16 v[26:29], v[96:99], v[14:17], 0
    v_mov_b32_dpp v40, v18 quad_perm:[0,1,2,3] row_mask:0xf bank_mask:1
    v_add_f32_dpp v39, v55, v39 row_ror:12 row_mask:0xf bank_mask:1
    v_add_f32_dpp v38, v52, v38 row_ror:8 row_mask:0xf bank_mask:1
    v_add_f32_dpp v37, v33, v37 row_ror:4 row_mask:0xf bank_mask:1
    s_waitcnt vmcnt(35)
    v_mfma_f32_16x16x32_bf16 v[30:33], v[100:103], v[14:17], 0
    v_mov_b32_dpp v41, v22 quad_perm:[0,1,2,3] row_mask:0xf bank_mask:1
    v_add_f32_dpp v40, v19, v40 row_ror:12 row_mask:0xf bank_mask:1
    v_add_f32_dpp v39, v56, v39 row_ror:8 row_mask:0xf bank_mask:1
    v_add_f32_dpp v38, v53, v38 row_ror:4 row_mask:0xf bank_mask:1
    s_waitcnt vmcnt(3)
    buffer_load_dwordx4 v[244:247], v1, s[4:7], s83 offen offset:1024 nt
    s_waitcnt vmcnt(35)
    v_mfma_f32_16x16x32_bf16 v[50:53], v[104:107], v[14:17], 0
    v_mov_b32_dpp v34, v27 quad_perm:[0,1,2,3] row_mask:0xf bank_mask:2
    v_add_f32_dpp v41, v23, v41 row_ror:12 row_mask:0xf bank_mask:1
    v_add_f32_dpp v40, v20, v40 row_ror:8 row_mask:0xf bank_mask:1
    v_add_f32_dpp v39, v57, v39 row_ror:4 row_mask:0xf bank_mask:1
    s_waitcnt vmcnt(34)
    v_mfma_f32_16x16x32_bf16 v[54:57], v[108:111], v[14:17], 0
    v_mov_b32_dpp v35, v31 quad_perm:[0,1,2,3] row_mask:0xf bank_mask:2
    v_add_f32_dpp v34, v28, v34 row_ror:12 row_mask:0xf bank_mask:2
    v_add_f32_dpp v41, v24, v41 row_ror:8 row_mask:0xf bank_mask:1
    v_add_f32_dpp v40, v21, v40 row_ror:4 row_mask:0xf bank_mask:1
    s_waitcnt vmcnt(3)
    buffer_load_dwordx4 v[248:251], v1, s[4:7], s83 offen offset:2048 nt
    s_waitcnt vmcnt(34)
    v_mfma_f32_16x16x32_bf16 v[18:21], v[112:115], v[14:17], 0
    v_mov_b32_dpp v36, v51 quad_perm:[0,1,2,3] row_mask:0xf bank_mask:2
    v_add_f32_dpp v35, v32, v35 row_ror:12 row_mask:0xf bank_mask:2
    v_add_f32_dpp v34, v29, v34 row_ror:8 row_mask:0xf bank_mask:2
    v_add_f32_dpp v41, v25, v41 row_ror:4 row_mask:0xf bank_mask:1
    s_waitcnt vmcnt(33)
    v_mfma_f32_16x16x32_bf16 v[22:25], v[116:119], v[14:17], 0
    v_mov_b32_dpp v37, v55 quad_perm:[0,1,2,3] row_mask:0xf bank_mask:2
    v_add_f32_dpp v36, v52, v36 row_ror:12 row_mask:0xf bank_mask:2
    v_add_f32_dpp v35, v33, v35 row_ror:8 row_mask:0xf bank_mask:2
    v_add_f32_dpp v34, v26, v34 row_ror:4 row_mask:0xf bank_mask:2
    s_waitcnt vmcnt(3)
    buffer_load_dwordx4 v[252:255], v1, s[4:7], s83 offen offset:3072 nt
    s_waitcnt vmcnt(33)
    v_mfma_f32_16x16x32_bf16 v[26:29], v[120:123], v[14:17], 0
    v_mov_b32_dpp v38, v19 quad_perm:[0,1,2,3] row_mask:0xf bank_mask:2
    v_add_f32_dpp v37, v56, v37 row_ror:12 row_mask:0xf bank_mask:2
    v_add_f32_dpp v36, v53, v36 row_ror:8 row_mask:0xf bank_mask:2
    v_add_f32_dpp v35, v30, v35 row_ror:4 row_mask:0xf bank_mask:2
    s_waitcnt vmcnt(32)
    v_mfma_f32_16x16x32_bf16 v[30:33], v[124:127], v[14:17], 0
    v_mov_b32_dpp v39, v23 quad_perm:[0,1,2,3] row_mask:0xf bank_mask:2
    v_add_f32_dpp v38, v20, v38 row_ror:12 row_mask:0xf bank_mask:2
    v_add_f32_dpp v37, v57, v37 row_ror:8 row_mask:0xf bank_mask:2
    v_add_f32_dpp v36, v50, v36 row_ror:4 row_mask:0xf bank_mask:2
    s_waitcnt vmcnt(3)
    s_add_u32 s84, s81, 0
    s_add_u32 m0, s80, 0
    s_nop 0
    buffer_load_dwordx4 v2, s[8:11], s84 offen offset:0 nt lds
    s_waitcnt vmcnt(32)
    v_mfma_f32_16x16x32_bf16 v[50:53], v[128:131], v[14:17], 0
    v_mov_b32_dpp v40, v27 quad_perm:[0,1,2,3] row_mask:0xf bank_mask:2
    v_add_f32_dpp v39, v24, v39 row_ror:12 row_mask:0xf bank_mask:2
    v_add_f32_dpp v38, v21, v38 row_ror:8 row_mask:0xf bank_mask:2
    v_add_f32_dpp v37, v54, v37 row_ror:4 row_mask:0xf bank_mask:2
    s_waitcnt vmcnt(31)
    v_mfma_f32_16x16x32_bf16 v[54:57], v[132:135], v[14:17], 0
    v_mov_b32_dpp v41, v31 quad_perm:[0,1,2,3] row_mask:0xf bank_mask:2
    v_add_f32_dpp v40, v28, v40 row_ror:12 row_mask:0xf bank_mask:2
    v_add_f32_dpp v39, v25, v39 row_ror:8 row_mask:0xf bank_mask:2
    v_add_f32_dpp v38, v18, v38 row_ror:4 row_mask:0xf bank_mask:2
    s_waitcnt vmcnt(3)
    buffer_load_dwordx4 v3, s[8:11], s84 offen offset:1024 nt lds
    s_waitcnt vmcnt(31)
    v_mfma_f32_16x16x32_bf16 v[18:21], v[136:139], v[14:17], 0
    v_mov_b32_dpp v34, v52 quad_perm:[0,1,2,3] row_mask:0xf bank_mask:4
    v_add_f32_dpp v41, v32, v41 row_ror:12 row_mask:0xf bank_mask:2
    v_add_f32_dpp v40, v29, v40 row_ror:8 row_mask:0xf bank_mask:2
    v_add_f32_dpp v39, v22, v39 row_ror:4 row_mask:0xf bank_mask:2
    s_waitcnt vmcnt(30)
    v_mfma_f32_16x16x32_bf16 v[22:25], v[140:143], v[14:17], 0
    v_mov_b32_dpp v35, v56 quad_perm:[0,1,2,3] row_mask:0xf bank_mask:4
    v_add_f32_dpp v34, v53, v34 row_ror:12 row_mask:0xf bank_mask:4
    v_add_f32_dpp v41, v33, v41 row_ror:8 row_mask:0xf bank_mask:2
    v_add_f32_dpp v40, v26, v40 row_ror:4 row_mask:0xf bank_mask:2
    s_waitcnt vmcnt(3)
    buffer_load_dwordx4 v4, s[8:11], s84 offen offset:2048 nt lds
    s_waitcnt vmcnt(30)
    v_mfma_f32_16x16x32_bf16 v[26:29], v[144:147], v[14:17], 0
    v_mov_b32_dpp v36, v20 quad_perm:[0,1,2,3] row_mask:0xf bank_mask:4
    v_add_f32_dpp v35, v57, v35 row_ror:12 row_mask:0xf bank_mask:4
    v_add_f32_dpp v34, v50, v34 row_ror:8 row_mask:0xf bank_mask:4
    v_add_f32_dpp v41, v30, v41 row_ror:4 row_mask:0xf bank_mask:2
    s_waitcnt vmcnt(29)
    v_mfma_f32_16x16x32_bf16 v[30:33], v[148:151], v[14:17], 0
    v_mov_b32_dpp v37, v24 quad_perm:[0,1,2,3] row_mask:0xf bank_mask:4
    v_add_f32_dpp v36, v21, v36 row_ror:12 row_mask:0xf bank_mask:4
    v_add_f32_dpp v35, v54, v35 row_ror:8 row_mask:0xf bank_mask:4
    v_add_f32_dpp v34, v51, v34 row_ror:4 row_mask:0xf bank_mask:4
    s_waitcnt vmcnt(3)
    buffer_load_dwordx4 v5, s[8:11], s84 offen offset:3072 nt lds
    s_waitcnt vmcnt(29)
    v_mfma_f32_16x16x32_bf16 v[50:53], v[152:155], v[14:17], 0
    v_mov_b32_dpp v38, v28 quad_perm:[0,1,2,3] row_mask:0xf bank_mask:4
    v_add_f32_dpp v37, v25, v37 row_ror:12 row_mask:0xf bank_mask:4
    v_add_f32_dpp v36, v18, v36 row_ror:8 row_mask:0xf bank_mask:4
    v_add_f32_dpp v35, v55, v35 row_ror:4 row_mask:0xf bank_mask:4
    s_waitcnt vmcnt(28)
    v_mfma_f32_16x16x32_bf16 v[54:57], v[156:159], v[14:17], 0
    v_mov_b32_dpp v39, v32 quad_perm:[0,1,2,3] row_mask:0xf bank_mask:4
    v_add_f32_dpp v38, v29, v38 row_ror:12 row_mask:0xf bank_mask:4
    v_add_f32_dpp v37, v22, v37 row_ror:8 row_mask:0xf bank_mask:4
    v_add_f32_dpp v36, v19, v36 row_ror:4 row_mask:0xf bank_mask:4
    s_waitcnt vmcnt(3)
    s_add_u32 s84, s81, 32768
    s_add_u32 m0, s80, 4096
    s_nop 0
    buffer_load_dwordx4 v2, s[8:11], s84 offen offset:0 nt lds
    s_waitcnt vmcnt(28)
    v_mfma_f32_16x16x32_bf16 v[18:21], v[160:163], v[14:17], 0
    v_mov_b32_dpp v40, v52 quad_perm:[0,1,2,3] row_mask:0xf bank_mask:4
    v_add_f32_dpp v39, v33, v39 row_ror:12 row_mask:0xf bank_mask:4
    v_add_f32_dpp v38, v26, v38 row_ror:8 row_mask:0xf bank_mask:4
    v_add_f32_dpp v37, v23, v37 row_ror:4 row_mask:0xf bank_mask:4
    s_waitcnt vmcnt(27)
    v_mfma_f32_16x16x32_bf16 v[22:25], v[164:167], v[14:17], 0
    v_mov_b32_dpp v41, v56 quad_perm:[0,1,2,3] row_mask:0xf bank_mask:4
    v_add_f32_dpp v40, v53, v40 row_ror:12 row_mask:0xf bank_mask:4
    v_add_f32_dpp v39, v30, v39 row_ror:8 row_mask:0xf bank_mask:4
    v_add_f32_dpp v38, v27, v38 row_ror:4 row_mask:0xf bank_mask:4
    s_waitcnt vmcnt(3)
    buffer_load_dwordx4 v3, s[8:11], s84 offen offset:1024 nt lds
    s_waitcnt vmcnt(27)
    v_mfma_f32_16x16x32_bf16 v[26:29], v[168:171], v[14:17], 0
    v_mov_b32_dpp v34, v21 quad_perm:[0,1,2,3] row_mask:0xf bank_mask:8
    v_add_f32_dpp v41, v57, v41 row_ror:12 row_mask:0xf bank_mask:4
    v_add_f32_dpp v40, v50, v40 row_ror:8 row_mask:0xf bank_mask:4
    v_add_f32_dpp v39, v31, v39 row_ror:4 row_mask:0xf bank_mask:4
    s_waitcnt vmcnt(26)
    v_mfma_f32_16x16x32_bf16 v[30:33], v[172:175], v[14:17], 0
    v_mov_b32_dpp v35, v25 quad_perm:[0,1,2,3] row_mask:0xf bank_mask:8
    v_add_f32_dpp v34, v18, v34 row_ror:12 row_mask:0xf bank_mask:8
    v_add_f32_dpp v41, v54, v41 row_ror:8 row_mask:0xf bank_mask:4
    v_add_f32_dpp v40, v51, v40 row_ror:4 row_mask:0xf bank_mask:4
    s_waitcnt vmcnt(3)
    buffer_load_dwordx4 v4, s[8:11], s84 offen offset:2048 nt lds
    s_waitcnt vmcnt(26)
    v_mfma_f32_16x16x32_bf16 v[50:53], v[176:179], v[14:17], 0
    v_mov_b32_dpp v36, v29 quad_perm:[0,1,2,3] row_mask:0xf bank_mask:8
    v_add_f32_dpp v35, v22, v35 row_ror:12 row_mask:0xf bank_mask:8
    v_add_f32_dpp v34, v19, v34 row_ror:8 row_mask:0xf bank_mask:8
    v_add_f32_dpp v41, v55, v41 row_ror:4 row_mask:0xf bank_mask:4
    s_waitcnt vmcnt(25)
    v_mfma_f32_16x16x32_bf16 v[54:57], v[180:183], v[14:17], 0
    v_mov_b32_dpp v37, v33 quad_perm:[0,1,2,3] row_mask:0xf bank_mask:8
    v_add_f32_dpp v36, v26, v36 row_ror:12 row_mask:0xf bank_mask:8
    v_add_f32_dpp v35, v23, v35 row_ror:8 row_mask:0xf bank_mask:8
    v_add_f32_dpp v34, v20, v34 row_ror:4 row_mask:0xf bank_mask:8
    s_waitcnt vmcnt(3)
    buffer_load_dwordx4 v5, s[8:11], s84 offen offset:3072 nt lds
    s_waitcnt vmcnt(25)
    v_mfma_f32_16x16x32_bf16 v[18:21], v[184:187], v[14:17], 0
    v_mov_b32_dpp v38, v53 quad_perm:[0,1,2,3] row_mask:0xf bank_mask:8
    v_add_f32_dpp v37, v30, v37 row_ror:12 row_mask:0xf bank_mask:8
    v_add_f32_dpp v36, v27, v36 row_ror:8 row_mask:0xf bank_mask:8
    v_add_f32_dpp v35, v24, v35 row_ror:4 row_mask:0xf bank_mask:8
    s_waitcnt vmcnt(24)
    v_mfma_f32_16x16x32_bf16 v[22:25], v[188:191], v[14:17], 0
    v_mov_b32_dpp v39, v57 quad_perm:[0,1,2,3] row_mask:0xf bank_mask:8
    v_add_f32_dpp v38, v50, v38 row_ror:12 row_mask:0xf bank_mask:8
    v_add_f32_dpp v37, v31, v37 row_ror:8 row_mask:0xf bank_mask:8
    v_add_f32_dpp v36, v28, v36 row_ror:4 row_mask:0xf bank_mask:8
    s_waitcnt vmcnt(3)
    s_add_u32 s84, s81, 65536
    s_add_u32 m0, s80, 8192
    s_nop 0
    buffer_load_dwordx4 v2, s[8:11], s84 offen offset:0 nt lds
    s_waitcnt vmcnt(24)
    v_mfma_f32_16x16x32_bf16 v[26:29], v[192:195], v[14:17], 0
    v_mov_b32_dpp v40, v21 quad_perm:[0,1,2,3] row_mask:0xf bank_mask:8
    v_add_f32_dpp v39, v54, v39 row_ror:12 row_mask:0xf bank_mask:8
    v_add_f32_dpp v38, v51, v38 row_ror:8 row_mask:0xf bank_mask:8
    v_add_f32_dpp v37, v32, v37 row_ror:4 row_mask:0xf bank_mask:8
    s_waitcnt vmcnt(23)
    v_mfma_f32_16x16x32_bf16 v[30:33], v[196:199], v[14:17], 0
    v_mov_b32_dpp v41, v25 quad_perm:[0,1,2,3] row_mask:0xf bank_mask:8
    v_add_f32_dpp v40, v18, v40 row_ror:12 row_mask:0xf bank_mask:8
    v_add_f32_dpp v39, v55, v39 row_ror:8 row_mask:0xf bank_mask:8
    v_add_f32_dpp v38, v52, v38 row_ror:4 row_mask:0xf bank_mask:8
    s_waitcnt vmcnt(3)
    buffer_load_dwordx4 v3, s[8:11], s84 offen offset:1024 nt lds
    s_waitcnt vmcnt(23)
    v_mfma_f32_16x16x32_bf16 v[50:53], v[200:203], v[14:17], 0
    v_mov_b32_dpp v42, v26 quad_perm:[0,1,2,3] row_mask:0xf bank_mask:1
    v_add_f32_dpp v41, v22, v41 row_ror:12 row_mask:0xf bank_mask:8
    v_add_f32_dpp v40, v19, v40 row_ror:8 row_mask:0xf bank_mask:8
    v_add_f32_dpp v39, v56, v39 row_ror:4 row_mask:0xf bank_mask:8
    s_waitcnt vmcnt(22)
    v_mfma_f32_16x16x32_bf16 v[54:57], v[204:207], v[14:17], 0
    v_mov_b32_dpp v43, v30 quad_perm:[0,1,2,3] row_mask:0xf bank_mask:1
    v_add_f32_dpp v42, v27, v42 row_ror:12 row_mask:0xf bank_mask:1
    v_add_f32_dpp v41, v23, v41 row_ror:8 row_mask:0xf bank_mask:8
    v_add_f32_dpp v40, v20, v40 row_ror:4 row_mask:0xf bank_mask:8
    s_waitcnt vmcnt(3)
    buffer_load_dwordx4 v4, s[8:11], s84 offen offset:2048 nt lds
    s_waitcnt vmcnt(22)
    v_mfma_f32_16x16x32_bf16 v[18:21], v[208:211], v[14:17], 0
    v_mov_b32_dpp v44, v50 quad_perm:[0,1,2,3] row_mask:0xf bank_mask:1
    v_add_f32_dpp v43, v31, v43 row_ror:12 row_mask:0xf bank_mask:1
    v_add_f32_dpp v42, v28, v42 row_ror:8 row_mask:0xf bank_mask:1
    v_add_f32_dpp v41, v24, v41 row_ror:4 row_mask:0xf bank_mask:8
    s_waitcnt vmcnt(21)
    v_mfma_f32_16x16x32_bf16 v[22:25], v[212:215], v[14:17], 0
    v_mov_b32_dpp v45, v54 quad_perm:[0,1,2,3] row_mask:0xf bank_mask:1
    v_add_f32_dpp v44, v51, v44 row_ror:12 row_mask:0xf bank_mask:1
    v_add_f32_dpp v43, v32, v43 row_ror:8 row_mask:0xf bank_mask:1
    v_add_f32_dpp v42, v29, v42 row_ror:4 row_mask:0xf bank_mask:1
    s_waitcnt vmcnt(3)
    buffer_load_dwordx4 v5, s[8:11], s84 offen offset:3072 nt lds
    s_waitcnt vmcnt(21)
    v_mfma_f32_16x16x32_bf16 v[26:29], v[216:219], v[14:17], 0
    v_mov_b32_dpp v46, v18 quad_perm:[0,1,2,3] row_mask:0xf bank_mask:1
    v_add_f32_dpp v45, v55, v45 row_ror:12 row_mask:0xf bank_mask:1
    v_add_f32_dpp v44, v52, v44 row_ror:8 row_mask:0xf bank_mask:1
    v_add_f32_dpp v43, v33, v43 row_ror:4 row_mask:0xf bank_mask:1
    s_waitcnt vmcnt(20)
    v_mfma_f32_16x16x32_bf16 v[30:33], v[220:223], v[14:17], 0
    v_mov_b32_dpp v47, v22 quad_perm:[0,1,2,3] row_mask:0xf bank_mask:1
    v_add_f32_dpp v46, v19, v46 row_ror:12 row_mask:0xf bank_mask:1
    v_add_f32_dpp v45, v56, v45 row_ror:8 row_mask:0xf bank_mask:1
    v_add_f32_dpp v44, v53, v44 row_ror:4 row_mask:0xf bank_mask:1
    s_waitcnt vmcnt(3)
    s_add_u32 s84, s81, 98304
    s_add_u32 m0, s80, 12288
    s_nop 0
    buffer_load_dwordx4 v2, s[8:11], s84 offen offset:0 nt lds
    s_waitcnt vmcnt(20)
    v_mfma_f32_16x16x32_bf16 v[50:53], v[224:227], v[14:17], 0
    v_mov_b32_dpp v48, v26 quad_perm:[0,1,2,3] row_mask:0xf bank_mask:1
    v_add_f32_dpp v47, v23, v47 row_ror:12 row_mask:0xf bank_mask:1
    v_add_f32_dpp v46, v20, v46 row_ror:8 row_mask:0xf bank_mask:1
    v_add_f32_dpp v45, v57, v45 row_ror:4 row_mask:0xf bank_mask:1
    s_waitcnt vmcnt(3)
    buffer_load_dwordx4 v3, s[8:11], s84 offen offset:1024 nt lds
    s_waitcnt vmcnt(20)
    v_mfma_f32_16x16x32_bf16 v[54:57], v[228:231], v[14:17], 0
    v_mov_b32_dpp v49, v30 quad_perm:[0,1,2,3] row_mask:0xf bank_mask:1
    v_add_f32_dpp v48, v27, v48 row_ror:12 row_mask:0xf bank_mask:1
    v_add_f32_dpp v47, v24, v47 row_ror:8 row_mask:0xf bank_mask:1
    v_add_f32_dpp v46, v21, v46 row_ror:4 row_mask:0xf bank_mask:1
    s_waitcnt vmcnt(3)
    buffer_load_dwordx4 v4, s[8:11], s84 offen offset:2048 nt lds
    s_waitcnt vmcnt(20)
    v_mfma_f32_16x16x32_bf16 v[18:21], v[232:235], v[14:17], 0
    v_mov_b32_dpp v42, v51 quad_perm:[0,1,2,3] row_mask:0xf bank_mask:2
    v_add_f32_dpp v49, v31, v49 row_ror:12 row_mask:0xf bank_mask:1
    v_add_f32_dpp v48, v28, v48 row_ror:8 row_mask:0xf bank_mask:1
    v_add_f32_dpp v47, v25, v47 row_ror:4 row_mask:0xf bank_mask:1
    s_waitcnt vmcnt(3)
    buffer_load_dwordx4 v5, s[8:11], s84 offen offset:3072 nt lds
    s_waitcnt vmcnt(20)
    v_mfma_f32_16x16x32_bf16 v[22:25], v[236:239], v[14:17], 0
    v_mov_b32_dpp v43, v55 quad_perm:[0,1,2,3] row_mask:0xf bank_mask:2
    v_add_f32_dpp v42, v52, v42 row_ror:12 row_mask:0xf bank_mask:2
    v_add_f32_dpp v49, v32, v49 row_ror:8 row_mask:0xf bank_mask:1
    v_add_f32_dpp v48, v29, v48 row_ror:4 row_mask:0xf bank_mask:1
    s_waitcnt vmcnt(19)
    v_mfma_f32_16x16x32_bf16 v[26:29], v[240:243], v[14:17], 0
    v_mov_b32_dpp v44, v19 quad_perm:[0,1,2,3] row_mask:0xf bank_mask:2
    v_add_f32_dpp v43, v56, v43 row_ror:12 row_mask:0xf bank_mask:2
    v_add_f32_dpp v42, v53, v42 row_ror:8 row_mask:0xf bank_mask:2
    v_add_f32_dpp v49, v33, v49 row_ror:4 row_mask:0xf bank_mask:1
    s_waitcnt vmcnt(18)
    v_mfma_f32_16x16x32_bf16 v[30:33], v[244:247], v[14:17], 0
    v_mov_b32_dpp v45, v23 quad_perm:[0,1,2,3] row_mask:0xf bank_mask:2
    v_add_f32_dpp v44, v20, v44 row_ror:12 row_mask:0xf bank_mask:2
    v_add_f32_dpp v43, v57, v43 row_ror:8 row_mask:0xf bank_mask:2
    v_add_f32_dpp v42, v50, v42 row_ror:4 row_mask:0xf bank_mask:2
    s_waitcnt vmcnt(17)
    v_mfma_f32_16x16x32_bf16 v[50:53], v[248:251], v[14:17], 0
    v_mov_b32_dpp v46, v27 quad_perm:[0,1,2,3] row_mask:0xf bank_mask:2
    v_add_f32_dpp v45, v24, v45 row_ror:12 row_mask:0xf bank_mask:2
    v_add_f32_dpp v44, v21, v44 row_ror:8 row_mask:0xf bank_mask:2
    v_add_f32_dpp v43, v54, v43 row_ror:4 row_mask:0xf bank_mask:2
    s_waitcnt vmcnt(16)
    v_mfma_f32_16x16x32_bf16 v[54:57], v[252:255], v[14:17], 0
    v_mov_b32_dpp v47, v31 quad_perm:[0,1,2,3] row_mask:0xf bank_mask:2
    v_add_f32_dpp v46, v28, v46 row_ror:12 row_mask:0xf bank_mask:2
    v_add_f32_dpp v45, v25, v45 row_ror:8 row_mask:0xf bank_mask:2
    v_add_f32_dpp v44, v18, v44 row_ror:4 row_mask:0xf bank_mask:2
    s_nop 0
    v_mov_b32_dpp v48, v51 quad_perm:[0,1,2,3] row_mask:0xf bank_mask:2
    v_add_f32_dpp v47, v32, v47 row_ror:12 row_mask:0xf bank_mask:2
    v_add_f32_dpp v46, v29, v46 row_ror:8 row_mask:0xf bank_mask:2
    v_add_f32_dpp v45, v22, v45 row_ror:4 row_mask:0xf bank_mask:2
    s_nop 0
    v_mov_b32_dpp v49, v55 quad_perm:[0,1,2,3] row_mask:0xf bank_mask:2
    v_add_f32_dpp v48, v52, v48 row_ror:12 row_mask:0xf bank_mask:2
    v_add_f32_dpp v47, v33, v47 row_ror:8 row_mask:0xf bank_mask:2
    v_add_f32_dpp v46, v26, v46 row_ror:4 row_mask:0xf bank_mask:2
    s_nop 0
    s_nop 0
    v_add_f32_dpp v49, v56, v49 row_ror:12 row_mask:0xf bank_mask:2
    v_add_f32_dpp v48, v53, v48 row_ror:8 row_mask:0xf bank_mask:2
    v_add_f32_dpp v47, v30, v47 row_ror:4 row_mask:0xf bank_mask:2
    s_nop 0
    s_nop 0
    s_nop 0
    v_add_f32_dpp v49, v57, v49 row_ror:8 row_mask:0xf bank_mask:2
    v_add_f32_dpp v48, v50, v48 row_ror:4 row_mask:0xf bank_mask:2
    s_nop 0
    s_nop 0
    s_nop 0
    s_nop 0
    v_add_f32_dpp v49, v54, v49 row_ror:4 row_mask:0xf bank_mask:2
    s_nop 0
    s_nop 0
    s_nop 0
    s_nop 0
    s_nop 0
    s_mov_b32 s86, 1035273459
    s_mov_b32 s87, 1069066811
    s_mov_b32 s88, 0xffff0000
    v_cvt_pk_bf16_f32 v50, v34, v35
    v_lshlrev_b32 v34, 16, v50
    v_and_b32 v35, s88, v50
    v_mul_f32 v34, s86, v34
    v_mul_f32 v35, s86, v35
    v_cvt_pk_bf16_f32 v50, v34, v35
    v_lshlrev_b32 v34, 16, v50
    v_and_b32 v35, s88, v50
    v_cvt_pk_bf16_f32 v51, v36, v37
    v_lshlrev_b32 v36, 16, v51
    v_and_b32 v37, s88, v51
    v_mul_f32 v36, s86, v36
    v_mul_f32 v37, s86, v37
    v_cvt_pk_bf16_f32 v51, v36, v37
    v_lshlrev_b32 v36, 16, v51
    v_and_b32 v37, s88, v51
    v_cvt_pk_bf16_f32 v52, v38, v39
    v_lshlrev_b32 v38, 16, v52
    v_and_b32 v39, s88, v52
    v_mul_f32 v38, s86, v38
    v_mul_f32 v39, s86, v39
    v_cvt_pk_bf16_f32 v52, v38, v39
    v_lshlrev_b32 v38, 16, v52
    v_and_b32 v39, s88, v52
    v_cvt_pk_bf16_f32 v53, v40, v41
    v_lshlrev_b32 v40, 16, v53
    v_and_b32 v41, s88, v53
    v_mul_f32 v40, s86, v40
    v_mul_f32 v41, s86, v41
    v_cvt_pk_bf16_f32 v53, v40, v41
    v_lshlrev_b32 v40, 16, v53
    v_and_b32 v41, s88, v53
    v_cvt_pk_bf16_f32 v50, v42, v43
    v_lshlrev_b32 v42, 16, v50
    v_and_b32 v43, s88, v50
    v_mul_f32 v42, s86, v42
    v_mul_f32 v43, s86, v43
    v_cvt_pk_bf16_f32 v50, v42, v43
    v_lshlrev_b32 v42, 16, v50
    v_and_b32 v43, s88, v50
    v_cvt_pk_bf16_f32 v51, v44, v45
    v_lshlrev_b32 v44, 16, v51
    v_and_b32 v45, s88, v51
    v_mul_f32 v44, s86, v44
    v_mul_f32 v45, s86, v45
    v_cvt_pk_bf16_f32 v51, v44, v45
    v_lshlrev_b32 v44, 16, v51
    v_and_b32 v45, s88, v51
    v_cvt_pk_bf16_f32 v52, v46, v47
    v_lshlrev_b32 v46, 16, v52
    v_and_b32 v47, s88, v52
    v_mul_f32 v46, s86, v46
    v_mul_f32 v47, s86, v47
    v_cvt_pk_bf16_f32 v52, v46, v47
    v_lshlrev_b32 v46, 16, v52
    v_and_b32 v47, s88, v52
    v_cvt_pk_bf16_f32 v53, v48, v49
    v_lshlrev_b32 v48, 16, v53
    v_and_b32 v49, s88, v53
    v_mul_f32 v48, s86, v48
    v_mul_f32 v49, s86, v49
    v_cvt_pk_bf16_f32 v53, v48, v49
    v_lshlrev_b32 v48, 16, v53
    v_and_b32 v49, s88, v53
    v_max3_f32 v60, v34, v35, v36
    v_max3_f32 v51, v37, v38, v39
    v_max3_f32 v52, v40, v41, v42
    v_max3_f32 v53, v43, v44, v45
    v_max3_f32 v60, v60, v46, v47
    v_max3_f32 v51, v51, v48, v49
    v_max3_f32 v60, v60, v51, v52
    v_max_f32 v60, v60, v53
    s_nop 1
    v_max_f32_dpp v60, v60, v60 row_ror:4 row_mask:0xf bank_mask:0xf
    s_nop 1
    v_max_f32_dpp v60, v60, v60 row_ror:8 row_mask:0xf bank_mask:0xf
    v_mov_b32 v51, v60
    s_nop 1
    v_permlane16_swap_b32 v60, v51
    v_max_f32 v60, v60, v51
    v_mov_b32 v51, v60
    s_nop 1
    v_permlane32_swap_b32 v60, v51
    v_max_f32 v60, v60, v51
    v_mul_f32 v52, s87, v60
    v_sub_f32 v52, 0, v52
    v_fma_f32 v34, v34, s87, v52
    v_fma_f32 v35, v35, s87, v52
    v_fma_f32 v36, v36, s87, v52
    v_fma_f32 v37, v37, s87, v52
    v_fma_f32 v38, v38, s87, v52
    v_fma_f32 v39, v39, s87, v52
    v_fma_f32 v40, v40, s87, v52
    v_fma_f32 v41, v41, s87, v52
    v_fma_f32 v42, v42, s87, v52
    v_fma_f32 v43, v43, s87, v52
    v_fma_f32 v44, v44, s87, v52
    v_fma_f32 v45, v45, s87, v52
    v_fma_f32 v46, v46, s87, v52
    v_fma_f32 v47, v47, s87, v52
    v_fma_f32 v48, v48, s87, v52
    v_fma_f32 v49, v49, s87, v52
    v_exp_f32 v34, v34
    v_exp_f32 v35, v35
    v_exp_f32 v36, v36
    v_exp_f32 v37, v37
    v_exp_f32 v38, v38
    v_exp_f32 v39, v39
    v_exp_f32 v40, v40
    v_exp_f32 v41, v41
    v_exp_f32 v42, v42
    v_exp_f32 v43, v43
    v_exp_f32 v44, v44
    v_exp_f32 v45, v45
    v_exp_f32 v46, v46
    v_exp_f32 v47, v47
    v_exp_f32 v48, v48
    v_exp_f32 v49, v49
    v_mov_b32 v64, 0
    v_mov_b32 v65, 0
    v_mov_b32 v66, 0
    v_mov_b32 v67, 0
    v_mov_b32 v68, 0
    v_mov_b32 v69, 0
    v_mov_b32 v70, 0
    v_mov_b32 v71, 0
    v_mov_b32 v72, 0
    v_mov_b32 v73, 0
    v_mov_b32 v74, 0
    v_mov_b32 v75, 0
    v_mov_b32 v76, 0
    v_mov_b32 v77, 0
    v_mov_b32 v78, 0
    v_mov_b32 v79, 0
    v_mov_b32 v80, 0
    v_mov_b32 v81, 0
    v_mov_b32 v82, 0
    v_mov_b32 v83, 0
    v_mov_b32 v84, 0
    v_mov_b32 v85, 0
    v_mov_b32 v86, 0
    v_mov_b32 v87, 0
    v_mov_b32 v88, 0
    v_mov_b32 v89, 0
    v_mov_b32 v90, 0
    v_mov_b32 v91, 0
    v_mov_b32 v92, 0
    v_mov_b32 v93, 0
    v_mov_b32 v94, 0
    v_mov_b32 v95, 0
    v_cvt_pk_bf16_f32 v18, v34, v35
    v_cvt_pk_bf16_f32 v19, v36, v37
    v_cvt_pk_bf16_f32 v20, v38, v39
    v_cvt_pk_bf16_f32 v21, v40, v41
    v_cvt_pk_bf16_f32 v22, v42, v43
    v_cvt_pk_bf16_f32 v23, v44, v45
    v_cvt_pk_bf16_f32 v24, v46, v47
    v_cvt_pk_bf16_f32 v25, v48, v49
    v_add_f32 v61, v34, v35
    v_add_f32 v61, v61, v36
    v_add_f32 v61, v61, v37
    v_add_f32 v61, v61, v38
    v_add_f32 v61, v61, v39
    v_add_f32 v61, v61, v40
    v_add_f32 v61, v61, v41
    v_add_f32 v61, v61, v42
    v_add_f32 v61, v61, v43
    v_add_f32 v61, v61, v44
    v_add_f32 v61, v61, v45
    v_add_f32 v61, v61, v46
    v_add_f32 v61, v61, v47
    v_add_f32 v61, v61, v48
    v_add_f32 v61, v61, v49
    v_mov_b32 v34, 0xff7fffff
    v_mov_b32 v35, 0xff7fffff
    v_mov_b32 v36, 0xff7fffff
    v_mov_b32 v37, 0xff7fffff
    v_mov_b32 v38, 0xff7fffff
    v_mov_b32 v39, 0xff7fffff
    v_mov_b32 v40, 0xff7fffff
    v_mov_b32 v41, 0xff7fffff
    s_cmp_eq_u32 s3, 2
    s_cbranch_scc1 L_glu2_0
L_glu2_ret0:
    s_waitcnt vmcnt(12)
    ds_read_b64_tr_b16 v[96:97], v6 offset:0
    ds_read_b64_tr_b16 v[100:101], v7 offset:0
    ds_read_b64_tr_b16 v[104:105], v8 offset:0
    ds_read_b64_tr_b16 v[108:109], v9 offset:0
    ds_read_b64_tr_b16 v[112:113], v10 offset:0
    ds_read_b64_tr_b16 v[116:117], v11 offset:0
    ds_read_b64_tr_b16 v[120:121], v12 offset:0
    ds_read_b64_tr_b16 v[124:125], v13 offset:0
    s_waitcnt lgkmcnt(0)
    s_waitcnt vmcnt(4)
    s_cbranch_vccnz P_1
    s_waitcnt vmcnt(3)
P_1:
    s_add_u32 s84, s81, 131072
    s_add_u32 m0, s80, 0
    s_nop 0
    buffer_load_dwordx4 v2, s[8:11], s84 offen offset:0 nt lds
    s_waitcnt vmcnt(4)
    s_cbranch_vccnz P_2
    s_waitcnt vmcnt(3)
P_2:
    buffer_load_dwordx4 v3, s[8:11], s84 offen offset:1024 nt lds
    s_waitcnt vmcnt(4)
    s_cbranch_vccnz P_3
    s_waitcnt vmcnt(3)
P_3:
    buffer_load_dwordx4 v4, s[8:11], s84 offen offset:2048 nt lds
    s_waitcnt vmcnt(4)
    s_cbranch_vccnz P_4
    s_waitcnt vmcnt(3)
P_4:
    buffer_load_dwordx4 v5, s[8:11], s84 offen offset:3072 nt lds
    s_waitcnt vmcnt(12)
    ds_read_b64_tr_b16 v[98:99], v6 offset:4096
    ds_read_b64_tr_b16 v[102:103], v7 offset:4096
    ds_read_b64_tr_b16 v[106:107], v8 offset:4096
    ds_read_b64_tr_b16 v[110:111], v9 offset:4096
    ds_read_b64_tr_b16 v[114:115], v10 offset:4096
    ds_read_b64_tr_b16 v[118:119], v11 offset:4096
    ds_read_b64_tr_b16 v[122:123], v12 offset:4096
    ds_read_b64_tr_b16 v[126:127], v13 offset:4096
    s_waitcnt lgkmcnt(0)
    s_waitcnt vmcnt(4)
    s_cbranch_vccnz P_5
    s_waitcnt vmcnt(3)
P_5:
    s_add_u32 s84, s81, 163840
    s_add_u32 m0, s80, 4096
    s_nop 0
    buffer_load_dwordx4 v2, s[8:11], s84 offen offset:0 nt lds
    s_waitcnt vmcnt(4)
    s_cbranch_vccnz P_6
    s_waitcnt vmcnt(3)
P_6:
    buffer_load_dwordx4 v3, s[8:11], s84 offen offset:1024 nt lds
    s_waitcnt vmcnt(4)
    s_cbranch_vccnz P_7
    s_waitcnt vmcnt(3)
P_7:
    buffer_load_dwordx4 v4, s[8:11], s84 offen offset:2048 nt lds
    s_waitcnt vmcnt(4)
    s_cbranch_vccnz P_8
    s_waitcnt vmcnt(3)
P_8:
    buffer_load_dwordx4 v5, s[8:11], s84 offen offset:3072 nt lds
    v_mfma_f32_16x16x32_bf16 v[64:67], v[96:99], v[18:21], v[64:67]
    v_mfma_f32_16x16x32_bf16 v[68:71], v[100:103], v[18:21], v[68:71]
    v_mfma_f32_16x16x32_bf16 v[72:75], v[104:107], v[18:21], v[72:75]
    v_mfma_f32_16x16x32_bf16 v[76:79], v[108:111], v[18:21], v[76:79]
    v_mfma_f32_16x16x32_bf16 v[80:83], v[112:115], v[18:21], v[80:83]
    v_mfma_f32_16x16x32_bf16 v[84:87], v[116:119], v[18:21], v[84:87]
    v_mfma_f32_16x16x32_bf16 v[88:91], v[120:123], v[18:21], v[88:91]
    v_mfma_f32_16x16x32_bf16 v[92:95], v[124:127], v[18:21], v[92:95]
    s_cmp_eq_u32 s3, 2
    s_cbranch_scc1 L_glu2_1
L_glu2_ret1:
    v_mov_b32_dpp v30, v18 row_ror:12 row_mask:0xf bank_mask:0xf
    v_mov_b32_dpp v31, v19 row_ror:12 row_mask:0xf bank_mask:0xf
    v_mov_b32_dpp v32, v20 row_ror:12 row_mask:0xf bank_mask:0xf
    v_mov_b32_dpp v33, v21 row_ror:12 row_mask:0xf bank_mask:0xf
    s_waitcnt vmcnt(12)
    ds_read_b64_tr_b16 v[128:129], v6 offset:8192
    ds_read_b64_tr_b16 v[132:133], v7 offset:8192
    ds_read_b64_tr_b16 v[136:137], v8 offset:8192
    ds_read_b64_tr_b16 v[140:141], v9 offset:8192
    ds_read_b64_tr_b16 v[144:145], v10 offset:8192
    ds_read_b64_tr_b16 v[148:149], v11 offset:8192
    ds_read_b64_tr_b16 v[152:153], v12 offset:8192
    ds_read_b64_tr_b16 v[156:157], v13 offset:8192
    s_waitcnt lgkmcnt(0)
    s_waitcnt vmcnt(4)
    s_cbranch_vccnz P_9
    s_waitcnt vmcnt(3)
P_9:
    s_add_u32 s84, s81, 196608
    s_add_u32 m0, s80, 8192
    s_nop 0
    buffer_load_dwordx4 v2, s[8:11], s84 offen offset:0 nt lds
    s_waitcnt vmcnt(4)
    s_cbranch_vccnz P_10
    s_waitcnt vmcnt(3)
P_10:
    buffer_load_dwordx4 v3, s[8:11], s84 offen offset:1024 nt lds
    s_waitcnt vmcnt(4)
    s_cbranch_vccnz P_11
    s_waitcnt vmcnt(3)
P_11:
    buffer_load_dwordx4 v4, s[8:11], s84 offen offset:2048 nt lds
    s_waitcnt vmcnt(4)
    s_cbranch_vccnz P_12
    s_waitcnt vmcnt(3)
P_12:
    buffer_load_dwordx4 v5, s[8:11], s84 offen offset:3072 nt lds
    s_waitcnt vmcnt(12)
    ds_read_b64_tr_b16 v[130:131], v6 offset:12288
    ds_read_b64_tr_b16 v[134:135], v7 offset:12288
    ds_read_b64_tr_b16 v[138:139], v8 offset:12288
    ds_read_b64_tr_b16 v[142:143], v9 offset:12288
    ds_read_b64_tr_b16 v[146:147], v10 offset:12288
    ds_read_b64_tr_b16 v[150:151], v11 offset:12288
    ds_read_b64_tr_b16 v[154:155], v12 offset:12288
    ds_read_b64_tr_b16 v[158:159], v13 offset:12288
    s_waitcnt lgkmcnt(0)
    s_waitcnt vmcnt(4)
    s_cbranch_vccnz P_13
    s_waitcnt vmcnt(3)
P_13:
    s_add_u32 s84, s81, 229376
    s_add_u32 m0, s80, 12288
    s_nop 0
    buffer_load_dwordx4 v2, s[8:11], s84 offen offset:0 nt lds
    s_waitcnt vmcnt(4)
    s_cbranch_vccnz P_14
    s_waitcnt vmcnt(3)
P_14:
    buffer_load_dwordx4 v3, s[8:11], s84 offen offset:1024 nt lds
    s_waitcnt vmcnt(4)
    s_cbranch_vccnz P_15
    s_waitcnt vmcnt(3)
P_15:
    buffer_load_dwordx4 v4, s[8:11], s84 offen offset:2048 nt lds
    s_waitcnt vmcnt(4)
    s_cbranch_vccnz P_16
    s_waitcnt vmcnt(3)
P_16:
    buffer_load_dwordx4 v5, s[8:11], s84 offen offset:3072 nt lds
    v_mfma_f32_16x16x32_bf16 v[64:67], v[128:131], v[30:33], v[64:67]
    v_mfma_f32_16x16x32_bf16 v[68:71], v[132:135], v[30:33], v[68:71]
    v_mfma_f32_16x16x32_bf16 v[72:75], v[136:139], v[30:33], v[72:75]
    v_mfma_f32_16x16x32_bf16 v[76:79], v[140:143], v[30:33], v[76:79]
    v_mfma_f32_16x16x32_bf16 v[80:83], v[144:147], v[30:33], v[80:83]
    v_mfma_f32_16x16x32_bf16 v[84:87], v[148:151], v[30:33], v[84:87]
    v_mfma_f32_16x16x32_bf16 v[88:91], v[152:155], v[30:33], v[88:91]
    v_mfma_f32_16x16x32_bf16 v[92:95], v[156:159], v[30:33], v[92:95]
    v_mov_b32_dpp v26, v18 row_ror:8 row_mask:0xf bank_mask:0xf
    v_mov_b32_dpp v27, v19 row_ror:8 row_mask:0xf bank_mask:0xf
    v_mov_b32_dpp v28, v20 row_ror:8 row_mask:0xf bank_mask:0xf
    v_mov_b32_dpp v29, v21 row_ror:8 row_mask:0xf bank_mask:0xf
    s_waitcnt vmcnt(12)
    ds_read_b64_tr_b16 v[96:97], v6 offset:0
    ds_read_b64_tr_b16 v[100:101], v7 offset:0
    ds_read_b64_tr_b16 v[104:105], v8 offset:0
    ds_read_b64_tr_b16 v[108:109], v9 offset:0
    ds_read_b64_tr_b16 v[112:113], v10 offset:0
    ds_read_b64_tr_b16 v[116:117], v11 offset:0
    ds_read_b64_tr_b16 v[120:121], v12 offset:0
    ds_read_b64_tr_b16 v[124:125], v13 offset:0
    s_waitcnt lgkmcnt(0)
    s_waitcnt vmcnt(4)
    s_cbranch_vccnz P_17
    s_waitcnt vmcnt(3)
P_17:
    s_add_u32 s84, s81, 262144
    s_add_u32 m0, s80, 0
    s_nop 0
    buffer_load_dwordx4 v2, s[8:11], s84 offen offset:0 nt lds
    s_waitcnt vmcnt(4)
    s_cbranch_vccnz P_18
    s_waitcnt vmcnt(3)
P_18:
    buffer_load_dwordx4 v3, s[8:11], s84 offen offset:1024 nt lds
    s_waitcnt vmcnt(4)
    s_cbranch_vccnz P_19
    s_waitcnt vmcnt(3)
P_19:
    buffer_load_dwordx4 v4, s[8:11], s84 offen offset:2048 nt lds
    s_waitcnt vmcnt(4)
    s_cbranch_vccnz P_20
    s_waitcnt vmcnt(3)
P_20:
    buffer_load_dwordx4 v5, s[8:11], s84 offen offset:3072 nt lds
    s_waitcnt vmcnt(12)
    ds_read_b64_tr_b16 v[98:99], v6 offset:4096
    ds_read_b64_tr_b16 v[102:103], v7 offset:4096
    ds_read_b64_tr_b16 v[106:107], v8 offset:4096
    ds_read_b64_tr_b16 v[110:111], v9 offset:4096
    ds_read_b64_tr_b16 v[114:115], v10 offset:4096
    ds_read_b64_tr_b16 v[118:119], v11 offset:4096
    ds_read_b64_tr_b16 v[122:123], v12 offset:4096
    ds_read_b64_tr_b16 v[126:127], v13 offset:4096
    s_waitcnt lgkmcnt(0)
    s_waitcnt vmcnt(4)
    s_cbranch_vccnz P_21
    s_waitcnt vmcnt(3)
P_21:
    s_add_u32 s84, s81, 294912
    s_add_u32 m0, s80, 4096
    s_nop 0
    buffer_load_dwordx4 v2, s[8:11], s84 offen offset:0 nt lds
    s_waitcnt vmcnt(4)
    s_cbranch_vccnz P_22
    s_waitcnt vmcnt(3)
P_22:
    buffer_load_dwordx4 v3, s[8:11], s84 offen offset:1024 nt lds
    s_waitcnt vmcnt(4)
    s_cbranch_vccnz P_23
    s_waitcnt vmcnt(3)
P_23:
    buffer_load_dwordx4 v4, s[8:11], s84 offen offset:2048 nt lds
    s_waitcnt vmcnt(4)
    s_cbranch_vccnz P_24
    s_waitcnt vmcnt(3)
P_24:
    buffer_load_dwordx4 v5, s[8:11], s84 offen offset:3072 nt lds
    v_mfma_f32_16x16x32_bf16 v[64:67], v[96:99], v[26:29], v[64:67]
    v_mfma_f32_16x16x32_bf16 v[68:71], v[100:103], v[26:29], v[68:71]
    v_mfma_f32_16x16x32_bf16 v[72:75], v[104:107], v[26:29], v[72:75]
    v_mfma_f32_16x16x32_bf16 v[76:79], v[108:111], v[26:29], v[76:79]
    v_mfma_f32_16x16x32_bf16 v[80:83], v[112:115], v[26:29], v[80:83]
    v_mfma_f32_16x16x32_bf16 v[84:87], v[116:119], v[26:29], v[84:87]
    v_mfma_f32_16x16x32_bf16 v[88:91], v[120:123], v[26:29], v[88:91]
    v_mfma_f32_16x16x32_bf16 v[92:95], v[124:127], v[26:29], v[92:95]
    v_mov_b32_dpp v30, v18 row_ror:4 row_mask:0xf bank_mask:0xf
    v_mov_b32_dpp v31, v19 row_ror:4 row_mask:0xf bank_mask:0xf
    v_mov_b32_dpp v32, v20 row_ror:4 row_mask:0xf bank_mask:0xf
    v_mov_b32_dpp v33, v21 row_ror:4 row_mask:0xf bank_mask:0xf
    s_waitcnt vmcnt(12)
    ds_read_b64_tr_b16 v[128:129], v6 offset:8192
    ds_read_b64_tr_b16 v[132:133], v7 offset:8192
    ds_read_b64_tr_b16 v[136:137], v8 offset:8192
    ds_read_b64_tr_b16 v[140:141], v9 offset:8192
    ds_read_b64_tr_b16 v[144:145], v10 offset:8192
    ds_read_b64_tr_b16 v[148:149], v11 offset:8192
    ds_read_b64_tr_b16 v[152:153], v12 offset:8192
    ds_read_b64_tr_b16 v[156:157], v13 offset:8192
    s_waitcnt lgkmcnt(0)
    s_waitcnt vmcnt(4)
    s_cbranch_vccnz P_25
    s_waitcnt vmcnt(3)
P_25:
    s_add_u32 s84, s81, 327680
    s_add_u32 m0, s80, 8192
    s_nop 0
    buffer_load_dwordx4 v2, s[8:11], s84 offen offset:0 nt lds
    s_waitcnt vmcnt(4)
    s_cbranch_vccnz P_26
    s_waitcnt vmcnt(3)
P_26:
    buffer_load_dwordx4 v3, s[8:11], s84 offen offset:1024 nt lds
    s_waitcnt vmcnt(4)
    s_cbranch_vccnz P_27
    s_waitcnt vmcnt(3)
P_27:
    buffer_load_dwordx4 v4, s[8:11], s84 offen offset:2048 nt lds
    s_waitcnt vmcnt(4)
    s_cbranch_vccnz P_28
    s_waitcnt vmcnt(3)
P_28:
    buffer_load_dwordx4 v5, s[8:11], s84 offen offset:3072 nt lds
    s_waitcnt vmcnt(12)
    ds_read_b64_tr_b16 v[130:131], v6 offset:12288
    ds_read_b64_tr_b16 v[134:135], v7 offset:12288
    ds_read_b64_tr_b16 v[138:139], v8 offset:12288
    ds_read_b64_tr_b16 v[142:143], v9 offset:12288
    ds_read_b64_tr_b16 v[146:147], v10 offset:12288
    ds_read_b64_tr_b16 v[150:151], v11 offset:12288
    ds_read_b64_tr_b16 v[154:155], v12 offset:12288
    ds_read_b64_tr_b16 v[158:159], v13 offset:12288
    s_waitcnt lgkmcnt(0)
    s_waitcnt vmcnt(4)
    s_cbranch_vccnz P_29
    s_waitcnt vmcnt(3)
P_29:
    s_add_u32 s84, s81, 360448
    s_add_u32 m0, s80, 12288
    s_nop 0
    buffer_load_dwordx4 v2, s[8:11], s84 offen offset:0 nt lds
    s_waitcnt vmcnt(4)
    s_cbranch_vccnz P_30
    s_waitcnt vmcnt(3)
P_30:
    buffer_load_dwordx4 v3, s[8:11], s84 offen offset:1024 nt lds
    s_waitcnt vmcnt(4)
    s_cbranch_vccnz P_31
    s_waitcnt vmcnt(3)
P_31:
    buffer_load_dwordx4 v4, s[8:11], s84 offen offset:2048 nt lds
    s_waitcnt vmcnt(4)
    s_cbranch_vccnz P_32
    s_waitcnt vmcnt(3)
P_32:
    buffer_load_dwordx4 v5, s[8:11], s84 offen offset:3072 nt lds
    v_mfma_f32_16x16x32_bf16 v[64:67], v[128:131], v[30:33], v[64:67]
    v_mfma_f32_16x16x32_bf16 v[68:71], v[132:135], v[30:33], v[68:71]
    v_mfma_f32_16x16x32_bf16 v[72:75], v[136:139], v[30:33], v[72:75]
    v_mfma_f32_16x16x32_bf16 v[76:79], v[140:143], v[30:33], v[76:79]
    v_mfma_f32_16x16x32_bf16 v[80:83], v[144:147], v[30:33], v[80:83]
    v_mfma_f32_16x16x32_bf16 v[84:87], v[148:151], v[30:33], v[84:87]
    v_mfma_f32_16x16x32_bf16 v[88:91], v[152:155], v[30:33], v[88:91]
    v_mfma_f32_16x16x32_bf16 v[92:95], v[156:159], v[30:33], v[92:95]
    s_waitcnt vmcnt(12)
    ds_read_b64_tr_b16 v[96:97], v6 offset:0
    ds_read_b64_tr_b16 v[100:101], v7 offset:0
    ds_read_b64_tr_b16 v[104:105], v8 offset:0
    ds_read_b64_tr_b16 v[108:109], v9 offset:0
    ds_read_b64_tr_b16 v[112:113], v10 offset:0
    ds_read_b64_tr_b16 v[116:117], v11 offset:0
    ds_read_b64_tr_b16 v[120:121], v12 offset:0
    ds_read_b64_tr_b16 v[124:125], v13 offset:0
    s_waitcnt lgkmcnt(0)
    s_waitcnt vmcnt(3)
    s_add_u32 s83, s81, 393216
    buffer_load_dwordx4 v[160:163], v1, s[4:7], s83 offen offset:0 nt
    s_waitcnt vmcnt(3)
    buffer_load_dwordx4 v[164:167], v1, s[4:7], s83 offen offset:1024 nt
    s_waitcnt vmcnt(3)
    buffer_load_dwordx4 v[168:171], v1, s[4:7], s83 offen offset:2048 nt
    s_waitcnt vmcnt(3)
    buffer_load_dwordx4 v[172:175], v1, s[4:7], s83 offen offset:3072 nt
    s_cmp_eq_u32 s3, 1
    s_cbranch_scc1 L_bal_0
L_bal_ret0:
    s_waitcnt vmcnt(12)
    ds_read_b64_tr_b16 v[98:99], v6 offset:4096
    ds_read_b64_tr_b16 v[102:103], v7 offset:4096
    ds_read_b64_tr_b16 v[106:107], v8 offset:4096
    ds_read_b64_tr_b16 v[110:111], v9 offset:4096
    ds_read_b64_tr_b16 v[114:115], v10 offset:4096
    ds_read_b64_tr_b16 v[118:119], v11 offset:4096
    ds_read_b64_tr_b16 v[122:123], v12 offset:4096
    ds_read_b64_tr_b16 v[126:127], v13 offset:4096
    s_waitcnt lgkmcnt(0)
    s_waitcnt vmcnt(3)
    s_add_u32 s83, s81, 425984
    buffer_load_dwordx4 v[176:179], v1, s[4:7], s83 offen offset:0 nt
    s_waitcnt vmcnt(3)
    buffer_load_dwordx4 v[180:183], v1, s[4:7], s83 offen offset:1024 nt
    s_waitcnt vmcnt(3)
    buffer_load_dwordx4 v[184:187], v1, s[4:7], s83 offen offset:2048 nt
    s_waitcnt vmcnt(3)
    buffer_load_dwordx4 v[188:191], v1, s[4:7], s83 offen offset:3072 nt
    v_mfma_f32_16x16x32_bf16 v[64:67], v[96:99], v[22:25], v[64:67]
    v_mfma_f32_16x16x32_bf16 v[68:71], v[100:103], v[22:25], v[68:71]
    v_mfma_f32_16x16x32_bf16 v[72:75], v[104:107], v[22:25], v[72:75]
    v_mfma_f32_16x16x32_bf16 v[76:79], v[108:111], v[22:25], v[76:79]
    v_mfma_f32_16x16x32_bf16 v[80:83], v[112:115], v[22:25], v[80:83]
    v_mfma_f32_16x16x32_bf16 v[84:87], v[116:119], v[22:25], v[84:87]
    v_mfma_f32_16x16x32_bf16 v[88:91], v[120:123], v[22:25], v[88:91]
    v_mfma_f32_16x16x32_bf16 v[92:95], v[124:127], v[22:25], v[92:95]
    s_cmp_eq_u32 s3, 1
    s_cbranch_scc1 L_bal_1
L_bal_ret1:
    v_mov_b32_dpp v30, v22 row_ror:12 row_mask:0xf bank_mask:0xf
    v_mov_b32_dpp v31, v23 row_ror:12 row_mask:0xf bank_mask:0xf
    v_mov_b32_dpp v32, v24 row_ror:12 row_mask:0xf bank_mask:0xf
    v_mov_b32_dpp v33, v25 row_ror:12 row_mask:0xf bank_mask:0xf
    s_waitcnt vmcnt(12)
    ds_read_b64_tr_b16 v[128:129], v6 offset:8192
    ds_read_b64_tr_b16 v[132:133], v7 offset:8192
    ds_read_b64_tr_b16 v[136:137], v8 offset:8192
    ds_read_b64_tr_b16 v[140:141], v9 offset:8192
    ds_read_b64_tr_b16 v[144:145], v10 offset:8192
    ds_read_b64_tr_b16 v[148:149], v11 offset:8192
    ds_read_b64_tr_b16 v[152:153], v12 offset:8192
    ds_read_b64_tr_b16 v[156:157], v13 offset:8192
    s_waitcnt lgkmcnt(0)
    s_waitcnt vmcnt(3)
    s_add_u32 s84, s81, 393216
    s_add_u32 m0, s80, 0
    s_nop 0
    buffer_load_dwordx4 v2, s[8:11], s84 offen offset:0 nt lds
    s_waitcnt vmcnt(3)
    buffer_load_dwordx4 v3, s[8:11], s84 offen offset:1024 nt lds
    s_waitcnt vmcnt(3)
    buffer_load_dwordx4 v4, s[8:11], s84 offen offset:2048 nt lds
    s_waitcnt vmcnt(3)
    buffer_load_dwordx4 v5, s[8:11], s84 offen offset:3072 nt lds
    s_cmp_eq_u32 s3, 1
    s_cbranch_scc1 L_bal_2
L_bal_ret2:
    s_waitcnt vmcnt(12)
    ds_read_b64_tr_b16 v[130:131], v6 offset:12288
    ds_read_b64_tr_b16 v[134:135], v7 offset:12288
    ds_read_b64_tr_b16 v[138:139], v8 offset:12288
    ds_read_b64_tr_b16 v[142:143], v9 offset:12288
    ds_read_b64_tr_b16 v[146:147], v10 offset:12288
    ds_read_b64_tr_b16 v[150:151], v11 offset:12288
    ds_read_b64_tr_b16 v[154:155], v12 offset:12288
    ds_read_b64_tr_b16 v[158:159], v13 offset:12288
    s_waitcnt lgkmcnt(0)
    s_waitcnt vmcnt(3)
    s_add_u32 s84, s81, 425984
    s_add_u32 m0, s80, 4096
    s_nop 0
    buffer_load_dwordx4 v2, s[8:11], s84 offen offset:0 nt lds
    s_waitcnt vmcnt(3)
    buffer_load_dwordx4 v3, s[8:11], s84 offen offset:1024 nt lds
    s_waitcnt vmcnt(3)
    buffer_load_dwordx4 v4, s[8:11], s84 offen offset:2048 nt lds
    s_waitcnt vmcnt(3)
    buffer_load_dwordx4 v5, s[8:11], s84 offen offset:3072 nt lds
    v_mfma_f32_16x16x32_bf16 v[64:67], v[128:131], v[30:33], v[64:67]
    v_mfma_f32_16x16x32_bf16 v[68:71], v[132:135], v[30:33], v[68:71]
    v_mfma_f32_16x16x32_bf16 v[72:75], v[136:139], v[30:33], v[72:75]
    v_mfma_f32_16x16x32_bf16 v[76:79], v[140:143], v[30:33], v[76:79]
    v_mfma_f32_16x16x32_bf16 v[80:83], v[144:147], v[30:33], v[80:83]
    v_mfma_f32_16x16x32_bf16 v[84:87], v[148:151], v[30:33], v[84:87]
    v_mfma_f32_16x16x32_bf16 v[88:91], v[152:155], v[30:33], v[88:91]
    v_mfma_f32_16x16x32_bf16 v[92:95], v[156:159], v[30:33], v[92:95]
    v_mov_b32 v50, 147488
    s_mov_b32 s85, 200000
L_dwait:
    ds_read_b128 v[52:55], v50
    s_waitcnt lgkmcnt(0)
    v_readfirstlane_b32 s86, v52
    v_readfirstlane_b32 s87, v54
    v_readfirstlane_b32 s77, v55
    s_sub_u32 s85, s85, 1
    s_cmp_eq_u32 s85, 0
    s_cbranch_scc1 L_dok
    s_cmp_lg_u32 s86, 0
    s_cbranch_scc1 L_dok
    s_sleep 2
    s_branch L_dwait
L_dok:
    s_add_u32 s88, s87, 7
    s_lshr_b32 s88, s88, 3
    s_lshl_b32 s86, s88, 3
    s_sub_u32 s86, s86, 8
    s_sub_u32 s75, s87, s86
    s_lshr_b32 s75, s75, 1
    s_lshl_b32 s77, s77, 12
    s_add_u32 s77, s77, s78
    s_lshl_b32 s86, s86, 12
    s_add_u32 s76, s77, s86
    s_mul_i32 s86, s75, s3
    s_lshl_b32 s86, s86, 10
    s_add_u32 s76, s76, s86
    s_lshl_b32 s86, s3, 12
    s_add_u32 s77, s77, s86
    s_mov_b32 s59, 0x7ff00000
    s_cmp_eq_u32 s88, 0
    s_cbranch_scc1 L_r2_2
    s_cmp_eq_u32 s88, 1
    s_cbranch_scc1 L_r2_3
    s_cmp_eq_u32 s88, 2
    s_cbranch_scc1 L_r2_4
    s_cmp_eq_u32 s88, 3
    s_cbranch_scc1 L_r2_5
    s_branch L_r2_6
L_stats:
    s_lshl_b32 s86, s3, 5
    s_add_u32 s86, s86, 149504
    v_lshlrev_b32 v53, 3, v0
    v_add_u32 v53, s86, v53
    v_mov_b32 v54, 147460
    v_mov_b32 v55, 1
    s_mov_b64 exec, 0xf
    ds_write_b64 v53, v[50:51]
    s_waitcnt lgkmcnt(0)
    s_mov_b64 exec, 1
    ds_add_rtn_u32 v56, v54, v55
    s_mov_b64 exec, -1
    s_waitcnt lgkmcnt(0)
    v_readfirstlane_b32 s86, v56
    s_cmp_lg_u32 s86, 7
    s_cbranch_scc1 L_nostats
    v_and_b32 v53, 31, v0
    v_lshlrev_b32 v53, 3, v53
    v_add_u32 v53, 149504, v53
    ds_read_b64 v[54:55], v53
    s_waitcnt lgkmcnt(0)
    v_mov_b32 v56, v54
    s_nop 1
    v_max_f32_dpp v56, v56, v56 row_ror:4 row_mask:0xf bank_mask:0xf
    s_nop 1
    v_max_f32_dpp v56, v56, v56 row_ror:8 row_mask:0xf bank_mask:0xf
    v_mov_b32 v57, v56
    s_nop 1
    v_permlane16_swap_b32 v56, v57
    v_max_f32 v56, v56, v57
    v_mov_b32 v57, v56
    s_nop 1
    v_permlane32_swap_b32 v56, v57
    v_max_f32 v56, v56, v57
    v_sub_f32 v57, v54, v56
    v_mul_f32 v57, s87, v57
    v_exp_f32 v57, v57
    s_nop 0
    v_mul_f32 v58, v57, v55
    s_nop 1
    v_add_f32_dpp v58, v58, v58 row_ror:4 row_mask:0xf bank_mask:0xf
    s_nop 1
    v_add_f32_dpp v58, v58, v58 row_ror:8 row_mask:0xf bank_mask:0xf
    v_mov_b32 v59, v58
    s_nop 1
    v_permlane16_swap_b32 v58, v59
    v_add_f32 v58, v58, v59
    v_mov_b32 v59, v58
    s_nop 1
    v_permlane32_swap_b32 v58, v59
    v_add_f32 v58, v58, v59
    v_mul_f32 v58, 0.5, v58
    v_and_b32 v59, 3, v0
    v_lshlrev_b32 v59, 5, v59
    v_bfe_u32 v60, v0, 2, 3
    v_lshl_add_u32 v59, v60, 2, v59
    v_add_u32 v59, 149760, v59
    ds_write_b32 v59, v57
    s_bfe_u32 s86, s79, 0x30002
    s_lshl_b32 s86, s86, 11
    s_lshr_b32 s88, s79, 5
    s_lshl_b32 s88, s88, 6
    s_add_u32 s86, s86, s88
    s_and_b32 s88, s79, 3
    s_lshl_b32 s88, s88, 4
    s_add_u32 s86, s86, s88
    s_add_u32 s86, s86, 196608
    v_lshlrev_b32 v53, 9, v0
    v_mov_b32 v57, v58
    v_mov_b32 v58, s70
    v_mov_b32 v59, s71
    s_mov_b64 exec, 0xf
    buffer_store_dwordx4 v[56:59], v53, s[12:15], s86 offen sc1
    s_mov_b64 exec, -1
    s_waitcnt lgkmcnt(0)
L_nostats:
    s_cmp_eq_u32 s69, 2
    s_cbranch_scc1 L_stats_ret_2
    s_cmp_eq_u32 s69, 3
    s_cbranch_scc1 L_stats_ret_3
    s_cmp_eq_u32 s69, 4
    s_cbranch_scc1 L_stats_ret_4
    s_cmp_eq_u32 s69, 5
    s_cbranch_scc1 L_stats_ret_5
    s_branch L_stats_ret_6
L_vdone:
    s_and_b32 s72, s70, 0xfff
    s_bfe_u32 s73, s70, 0xc000c
    s_and_b32 s74, s71, 0xfff
    s_bfe_u32 s75, s71, 0xc000c
    s_mov_b32 s76, 0xfffff000
    v_and_b32 v50, 3, v0
    v_mul_u32_u24 v50, 576, v50
    v_lshrrev_b32 v51, 4, v0
    v_lshl_add_u32 v50, v51, 4, v50
    v_add_u32 v50, s80, v50
    s_mov_b32 s86, 0x000f000f
    s_mov_b32 s87, 0x000f000f
    s_mov_b64 exec, s[86:87]
    s_nop 1
    ds_write_b128 v50, v[64:67] offset:0
    ds_write_b128 v50, v[68:71] offset:64
    ds_write_b128 v50, v[72:75] offset:128
    ds_write_b128 v50, v[76:79] offset:192
    ds_write_b128 v50, v[80:83] offset:256
    ds_write_b128 v50, v[84:87] offset:320
    ds_write_b128 v50, v[88:91] offset:384
    ds_write_b128 v50, v[92:95] offset:448
    s_mov_b64 exec, -1
    s_waitcnt lgkmcnt(0)
    s_cmp_lt_u32 s3, 4
    s_cbranch_scc1 L_bar1
    s_sub_u32 s43, s3, 4
    v_lshrrev_b32 v50, 5, v0
    s_lshl_b32 s86, s43, 1
    v_add_u32 v50, s86, v50
    v_and_b32 v51, 31, v0
    v_lshlrev_b32 v53, 11, v50
    v_lshl_add_u32 v53, v51, 4, v53
    s_lshl_b32 s92, s90, 14
    s_add_u32 s92, s92, 524288
    buffer_load_dwordx4 v[72:75], v53, s[12:15], s92 offen offset:0 sc1
    buffer_load_dwordx4 v[76:79], v53, s[12:15], s92 offen offset:512 sc1
    buffer_load_dwordx4 v[80:83], v53, s[12:15], s92 offen offset:1024 sc1
    buffer_load_dwordx4 v[84:87], v53, s[12:15], s92 offen offset:1536 sc1
L_bar1:
    s_barrier
    s_cmp_ge_u32 s3, 4
    s_cbranch_scc1 L_hop1
    s_cmp_eq_u32 s3, 2
    s_cbranch_scc1 L_epoch
    s_cmp_eq_u32 s3, 3
    s_cbranch_scc1 L_fin
    v_lshrrev_b32 v50, 5, v0
    s_lshl_b32 s86, s3, 1
    v_add_u32 v50, s86, v50
    v_and_b32 v51, 31, v0
    v_mul_u32_u24 v52, 576, v50
    v_lshl_add_u32 v52, v51, 4, v52
    v_lshlrev_b32 v53, 5, v50
    v_add_u32 v53, 149760, v53
    v_add_u32 v54, 0x10000, v52
    ds_read_b128 v[96:99], v53
    ds_read_b128 v[100:103], v53 offset:16
    ds_read_b128 v[64:67], v52 offset:0
    ds_read_b128 v[68:71], v52 offset:16384
    ds_read_b128 v[72:75], v52 offset:32768
    ds_read_b128 v[76:79], v52 offset:49152
    ds_read_b128 v[80:83], v54 offset:0
    ds_read_b128 v[84:87], v54 offset:16384
    ds_read_b128 v[88:91], v54 offset:32768
    ds_read_b128 v[92:95], v54 offset:49152
    s_bfe_u32 s86, s79, 0x30002
    s_lshl_b32 s86, s86, 16
    s_lshr_b32 s88, s79, 5
    s_lshl_b32 s88, s88, 11
    s_add_u32 s86, s86, s88
    s_and_b32 s88, s79, 3
    s_lshl_b32 s88, s88, 9
    s_add_u32 s86, s86, s88
    s_add_u32 s86, s86, 524288
    v_lshlrev_b32 v55, 14, v50
    v_lshl_add_u32 v55, v51, 4, v55
    s_waitcnt lgkmcnt(7)
    v_mul_f32 v104, v96, v64
    v_mul_f32 v105, v96, v65
    v_mul_f32 v106, v96, v66
    v_mul_f32 v107, v96, v67
    s_waitcnt lgkmcnt(6)
    v_fmac_f32 v104, v97, v68
    v_fmac_f32 v105, v97, v69
    v_fmac_f32 v106, v97, v70
    v_fmac_f32 v107, v97, v71
    s_waitcnt lgkmcnt(5)
    v_fmac_f32 v104, v98, v72
    v_fmac_f32 v105, v98, v73
    v_fmac_f32 v106, v98, v74
    v_fmac_f32 v107, v98, v75
    s_waitcnt lgkmcnt(4)
    v_fmac_f32 v104, v99, v76
    v_fmac_f32 v105, v99, v77
    v_fmac_f32 v106, v99, v78
    v_fmac_f32 v107, v99, v79
    s_waitcnt lgkmcnt(3)
    v_fmac_f32 v104, v100, v80
    v_fmac_f32 v105, v100, v81
    v_fmac_f32 v106, v100, v82
    v_fmac_f32 v107, v100, v83
    s_waitcnt lgkmcnt(2)
    v_fmac_f32 v104, v101, v84
    v_fmac_f32 v105, v101, v85
    v_fmac_f32 v106, v101, v86
    v_fmac_f32 v107, v101, v87
    s_waitcnt lgkmcnt(1)
    v_fmac_f32 v104, v102, v88
    v_fmac_f32 v105, v102, v89
    v_fmac_f32 v106, v102, v90
    v_fmac_f32 v107, v102, v91
    s_waitcnt lgkmcnt(0)
    v_fmac_f32 v104, v103, v92
    v_fmac_f32 v105, v103, v93
    v_fmac_f32 v106, v103, v94
    v_fmac_f32 v107, v103, v95
    v_add_u32 v104, 0x800, v104
    v_add_u32 v105, 0x800, v105
    v_add_u32 v106, 0x800, v106
    v_add_u32 v107, 0x800, v107
    v_and_b32 v104, s76, v104
    v_and_b32 v105, s76, v105
    v_and_b32 v106, s76, v106
    v_and_b32 v107, s76, v107
    v_or_b32 v104, s72, v104
    v_or_b32 v105, s73, v105
    v_or_b32 v106, s74, v106
    v_or_b32 v107, s75, v107
    buffer_store_dwordx4 v[104:107], v55, s[12:15], s86 offen sc1
    s_branch L_fin
L_touch:
    v_lshlrev_b32 v51, 7, v0
    s_lshl_b32 s86, s2, 13
    s_add_u32 s86, s86, 1048576
    buffer_load_dword v52, v51, s[12:15], s86 offen sc1
    s_branch L_fin
L_epoch:
    s_cmp_lg_u32 s2, 0
    s_cbranch_scc1 L_fin
    v_lshlrev_b32 v51, 4, v0
    s_mov_b32 s86, 245760
    s_mov_b32 s85, 200000
L_ep:
    buffer_load_dwordx4 v[64:67], v51, s[12:15], s86 offen offset:0 sc1
    buffer_load_dwordx4 v[68:71], v51, s[12:15], s86 offen offset:1024 sc1
    buffer_load_dwordx4 v[72:75], v51, s[12:15], s86 offen offset:2048 sc1
    buffer_load_dwordx4 v[76:79], v51, s[12:15], s86 offen offset:3072 sc1
    s_waitcnt vmcnt(0)
    s_mov_b64 s[56:57], 0
    v_cmp_ne_u64 s[92:93], s[70:71], v[66:67]
    s_or_b64 s[56:57], s[56:57], s[92:93]
    v_cmp_ne_u64 s[92:93], s[70:71], v[70:71]
    s_or_b64 s[56:57], s[56:57], s[92:93]
    v_cmp_ne_u64 s[92:93], s[70:71], v[74:75]
    s_or_b64 s[56:57], s[56:57], s[92:93]
    v_cmp_ne_u64 s[92:93], s[70:71], v[78:79]
    s_or_b64 s[56:57], s[56:57], s[92:93]
    s_cbranch_scc0 L_ep_ok
    s_sub_u32 s85, s85, 1
    s_cmp_eq_u32 s85, 0
    s_cbranch_scc1 L_ep_ok
    s_sleep 10
    s_branch L_ep
L_ep_ok:
    v_mov_b32 v56, s70
    v_mov_b32 v57, s71
    v_mov_b32 v51, 229376
    s_mov_b64 exec, 1
    buffer_store_dwordx2 v[56:57], v51, s[12:15], 0 offen sc1
    s_mov_b64 exec, -1
    s_branch L_fin
L_hop1:
    v_and_b32 v49, 3, v0
    v_lshlrev_b32 v52, 6, v50
    v_lshl_add_u32 v52, v49, 4, v52
    s_lshl_b32 s91, s90, 9
    s_add_u32 s91, s91, 196608
    s_mov_b32 s85, 200000
    s_lshl_b32 s86, s43, 5
    s_add_u32 s86, s86, 131072
    v_add_u32 v54, s86, v62
    v_bfe_u32 v48, v0, 2, 1
    v_lshlrev_b32 v48, 11, v48
    v_lshl_add_u32 v48, v49, 9, v48
    s_lshl_b32 s86, s43, 12
    v_add_u32 v48, s86, v48
    ds_read_b64_tr_b16 v[160:161], v54 offset:0
    ds_read_b64_tr_b16 v[162:163], v54 offset:512
    ds_read_b64_tr_b16 v[164:165], v54 offset:4096
    ds_read_b64_tr_b16 v[166:167], v54 offset:4608
    ds_read_b64_tr_b16 v[168:169], v54 offset:8192
    ds_read_b64_tr_b16 v[170:171], v54 offset:8704
    ds_read_b64_tr_b16 v[172:173], v54 offset:12288
    ds_read_b64_tr_b16 v[174:175], v54 offset:12800
    v_lshlrev_b32 v55, 4, v0
    s_lshl_b32 s86, s43, 10
    s_add_u32 s86, s86, 155648
    v_add_u32 v55, s86, v55
    ds_read_b128 v[120:123], v55
L_h1s:
    buffer_load_dwordx4 v[64:67], v52, s[12:15], s91 offen sc1
    s_waitcnt vmcnt(0)
    v_cmp_ne_u64 s[86:87], s[70:71], v[66:67]
    s_sub_u32 s85, s85, 1
    s_cmp_eq_u32 s85, 0
    s_cbranch_scc1 L_h1s_ok
    s_cmp_eq_u64 s[86:87], 0
    s_cbranch_scc1 L_h1s_ok
    s_sleep 6
    s_branch L_h1s
L_h1s_ok:
    s_mov_b32 s87, 1069066811
    v_max_f32_dpp v56, v64, v64 quad_perm:[1,0,3,2] row_mask:0xf bank_mask:0xf
    v_mul_u32_u24 v60, 272, v50
    v_lshl_add_u32 v60, v51, 3, v60
    v_max_f32_dpp v56, v56, v56 quad_perm:[2,3,0,1] row_mask:0xf bank_mask:0xf
    v_add_u32 v60, 151552, v60
    v_sub_f32 v64, v64, v56
    v_mul_f32 v64, s87, v64
    v_exp_f32 v64, v64
    v_and_b32 v61, 7, v0
    v_mul_f32 v57, v64, v65
    v_mul_u32_u24 v61, 272, v61
    v_lshrrev_b32 v55, 4, v0
    v_add_f32_dpp v57, v57, v57 quad_perm:[1,0,3,2] row_mask:0xf bank_mask:0xf
    v_lshl_add_u32 v61, v55, 4, v61
    v_add_u32 v61, 151552, v61
    v_add_f32_dpp v57, v57, v57 quad_perm:[2,3,0,1] row_mask:0xf bank_mask:0xf
    v_lshlrev_b32 v63, 17, v63
    v_rcp_f32 v57, v57
    v_lshl_add_u32 v63, v55, 4, v63
    v_mul_f32 v64, v64, v57
    s_lshl_b32 s93, s89, 2
    s_add_u32 s93, s93, s43
    s_lshl_b32 s93, s93, 12
    s_lshl_b32 s88, s90, 6
    s_add_u32 s93, s93, s88
    s_add_u32 s93, s93, 1048576
    v_mov_b32_dpp v68, v64 quad_perm:[0,0,0,0] row_mask:0xf bank_mask:0xf
    v_mov_b32_dpp v69, v64 quad_perm:[1,1,1,1] row_mask:0xf bank_mask:0xf
    v_mov_b32_dpp v70, v64 quad_perm:[2,2,2,2] row_mask:0xf bank_mask:0xf
    v_mov_b32_dpp v71, v64 quad_perm:[3,3,3,3] row_mask:0xf bank_mask:0xf
    s_waitcnt lgkmcnt(0)
    v_add_u32 v120, 0x800, v120
    v_add_u32 v121, 0x800, v121
    v_add_u32 v122, 0x800, v122
    v_add_u32 v123, 0x800, v123
    v_and_b32 v120, s76, v120
    v_and_b32 v121, s76, v121
    v_and_b32 v122, s76, v122
    v_and_b32 v123, s76, v123
    v_or_b32 v120, s72, v120
    v_or_b32 v121, s73, v121
    v_or_b32 v122, s74, v122
    v_or_b32 v123, s75, v123
    s_mov_b64 exec, s[60:61]
    buffer_store_dwordx4 v[120:123], v63, s[12:15], s93 offen offset:2048 sc1
    s_mov_b64 exec, -1
    s_branch L_h1chk
L_h1a:
    s_sleep 6
    buffer_load_dwordx4 v[44:47], v48, s[12:15], s92 offen offset:496 sc1
    s_waitcnt vmcnt(0)
    v_xor_b32 v88, s72, v44
    v_xor_b32 v89, s73, v45
    v_xor_b32 v90, s74, v46
    v_xor_b32 v91, s75, v47
    v_or3_b32 v88, v88, v89, v90
    v_or_b32 v88, v88, v91
    v_and_b32 v88, 0xfff, v88
    v_cmp_ne_u32 s[86:87], 0, v88
    s_sub_u32 s85, s85, 1
    s_cmp_eq_u32 s85, 0
    s_cbranch_scc1 L_h1o
    s_and_b32 s86, s86, 0xff
    s_bcnt1_i32_b32 s86, s86
    s_cmp_gt_u32 s86, 2
    s_cbranch_scc1 L_h1a
L_h1o:
    s_mov_b64 exec, s[52:53]
    s_cbranch_execz H_33
    buffer_load_dwordx4 v[72:75], v53, s[12:15], s92 offen offset:0 sc1
H_33:
    s_mov_b64 exec, s[54:55]
    s_cbranch_execz H_34
    buffer_load_dwordx4 v[76:79], v53, s[12:15], s92 offen offset:512 sc1
H_34:
    s_mov_b64 exec, s[56:57]
    s_cbranch_execz H_35
    buffer_load_dwordx4 v[80:83], v53, s[12:15], s92 offen offset:1024 sc1
H_35:
    s_mov_b64 exec, s[58:59]
    s_cbranch_execz H_36
    buffer_load_dwordx4 v[84:87], v53, s[12:15], s92 offen offset:1536 sc1
H_36:
    s_mov_b64 exec, -1
    s_waitcnt vmcnt(0)
L_h1chk:
    v_xor_b32 v88, s72, v72
    v_xor_b32 v89, s73, v73
    v_xor_b32 v90, s74, v74
    v_xor_b32 v91, s75, v75
    v_or3_b32 v88, v88, v89, v90
    v_or_b32 v88, v88, v91
    v_and_b32 v88, 0xfff, v88
    v_cmp_ne_u32 s[52:53], 0, v88
    v_xor_b32 v92, s72, v76
    v_xor_b32 v93, s73, v77
    v_xor_b32 v94, s74, v78
    v_xor_b32 v95, s75, v79
    v_or3_b32 v92, v92, v93, v94
    v_or_b32 v92, v92, v95
    v_and_b32 v92, 0xfff, v92
    v_cmp_ne_u32 s[54:55], 0, v92
    v_xor_b32 v96, s72, v80
    v_xor_b32 v97, s73, v81
    v_xor_b32 v98, s74, v82
    v_xor_b32 v99, s75, v83
    v_or3_b32 v96, v96, v97, v98
    v_or_b32 v96, v96, v99
    v_and_b32 v96, 0xfff, v96
    v_cmp_ne_u32 s[56:57], 0, v96
    v_xor_b32 v100, s72, v84
    v_xor_b32 v101, s73, v85
    v_xor_b32 v102, s74, v86
    v_xor_b32 v103, s75, v87
    v_or3_b32 v100, v100, v101, v102
    v_or_b32 v100, v100, v103
    v_and_b32 v100, 0xfff, v100
    v_cmp_ne_u32 s[58:59], 0, v100
    s_sub_u32 s85, s85, 1
    s_cmp_eq_u32 s85, 0
    s_cbranch_scc1 L_h1o_ok
    s_or_b64 s[86:87], s[52:53], s[54:55]
    s_or_b64 s[82:83], s[56:57], s[58:59]
    s_or_b64 s[86:87], s[86:87], s[82:83]
    s_cbranch_scc0 L_h1o_ok
    s_bcnt1_i32_b64 s86, s[52:53]
    s_bcnt1_i32_b64 s87, s[54:55]
    s_add_u32 s86, s86, s87
    s_bcnt1_i32_b64 s87, s[56:57]
    s_add_u32 s86, s86, s87
    s_bcnt1_i32_b64 s87, s[58:59]
    s_add_u32 s86, s86, s87
    s_cmp_gt_u32 s86, 64
    s_cbranch_scc1 L_h1a
    s_branch L_h1o
L_h1o_ok:
    v_and_b32 v72, s76, v72
    v_and_b32 v73, s76, v73
    v_and_b32 v74, s76, v74
    v_and_b32 v75, s76, v75
    v_and_b32 v76, s76, v76
    v_and_b32 v77, s76, v77
    v_and_b32 v78, s76, v78
    v_and_b32 v79, s76, v79
    v_and_b32 v80, s76, v80
    v_and_b32 v81, s76, v81
    v_and_b32 v82, s76, v82
    v_and_b32 v83, s76, v83
    v_and_b32 v84, s76, v84
    v_and_b32 v85, s76, v85
    v_and_b32 v86, s76, v86
    v_and_b32 v87, s76, v87
    v_mul_f32 v104, v68, v72
    v_mul_f32 v105, v68, v73
    v_mul_f32 v106, v68, v74
    v_mul_f32 v107, v68, v75
    v_fmac_f32 v104, v69, v76
    v_fmac_f32 v105, v69, v77
    v_fmac_f32 v106, v69, v78
    v_fmac_f32 v107, v69, v79
    v_fmac_f32 v104, v70, v80
    v_fmac_f32 v105, v70, v81
    v_fmac_f32 v106, v70, v82
    v_fmac_f32 v107, v70, v83
    v_fmac_f32 v104, v71, v84
    v_fmac_f32 v105, v71, v85
    v_fmac_f32 v106, v71, v86
    v_fmac_f32 v107, v71, v87
    v_cvt_pk_bf16_f32 v104, v104, v105
    v_cvt_pk_bf16_f32 v105, v106, v107
    ds_write_b64 v60, v[104:105]
    s_waitcnt lgkmcnt(0)
    s_barrier
    ds_read_b128 v[72:75], v61 offset:0
    ds_read_b128 v[76:79], v61 offset:64
    ds_read_b128 v[80:83], v61 offset:128
    ds_read_b128 v[84:87], v61 offset:192
    s_waitcnt lgkmcnt(3)
    v_mfma_f32_16x16x32_bf16 v[88:91], v[160:163], v[72:75], 0
    s_waitcnt lgkmcnt(2)
    v_mfma_f32_16x16x32_bf16 v[88:91], v[164:167], v[76:79], v[88:91]
    s_waitcnt lgkmcnt(1)
    v_mfma_f32_16x16x32_bf16 v[88:91], v[168:171], v[80:83], v[88:91]
    s_waitcnt lgkmcnt(0)
    v_mfma_f32_16x16x32_bf16 v[88:91], v[172:175], v[84:87], v[88:91]
    s_mov_b64 exec, s[60:61]
    s_lshl_b32 s86, s2, 12
    s_add_u32 s86, s86, 1048576
    s_mov_b32 s85, 200000
    s_nop 3
    v_add_u32 v88, 0x800, v88
    v_add_u32 v89, 0x800, v89
    v_add_u32 v90, 0x800, v90
    v_add_u32 v91, 0x800, v91
    v_and_b32 v88, s76, v88
    v_and_b32 v89, s76, v89
    v_and_b32 v90, s76, v90
    v_and_b32 v91, s76, v91
    v_or_b32 v88, s72, v88
    v_or_b32 v89, s73, v89
    v_or_b32 v90, s74, v90
    v_or_b32 v91, s75, v91
    buffer_store_dwordx4 v[88:91], v63, s[12:15], s93 offen sc1
    s_mov_b64 exec, -1
    s_cmp_lg_u32 s3, 4
    s_cbranch_scc1 L_fin
    v_lshlrev_b32 v50, 4, v0
    v_mov_b32 v52, 147472
    ds_read_b32 v53, v52
    s_mov_b64 s[52:53], -1
    s_mov_b64 s[54:55], -1
    s_mov_b64 s[56:57], -1
    s_mov_b64 s[58:59], -1
L_h2:
    s_mov_b64 exec, s[52:53]
    s_cbranch_execz H_37
    buffer_load_dwordx4 v[128:131], v50, s[12:15], s86 offen offset:0 sc1
H_37:
    s_mov_b64 exec, s[54:55]
    s_cbranch_execz H_38
    buffer_load_dwordx4 v[132:135], v50, s[12:15], s86 offen offset:1024 sc1
H_38:
    s_mov_b64 exec, s[56:57]
    s_cbranch_execz H_39
    buffer_load_dwordx4 v[136:139], v50, s[12:15], s86 offen offset:2048 sc1
H_39:
    s_mov_b64 exec, s[58:59]
    s_cbranch_execz H_40
    buffer_load_dwordx4 v[140:143], v50, s[12:15], s86 offen offset:3072 sc1
H_40:
    s_mov_b64 exec, -1
    s_waitcnt vmcnt(0)
    v_xor_b32 v72, s72, v128
    v_xor_b32 v73, s73, v129
    v_xor_b32 v74, s74, v130
    v_xor_b32 v75, s75, v131
    v_or3_b32 v72, v72, v73, v74
    v_or_b32 v72, v72, v75
    v_and_b32 v72, 0xfff, v72
    v_cmp_ne_u32 s[52:53], 0, v72
    v_xor_b32 v76, s72, v132
    v_xor_b32 v77, s73, v133
    v_xor_b32 v78, s74, v134
    v_xor_b32 v79, s75, v135
    v_or3_b32 v76, v76, v77, v78
    v_or_b32 v76, v76, v79
    v_and_b32 v76, 0xfff, v76
    v_cmp_ne_u32 s[54:55], 0, v76
    v_xor_b32 v80, s72, v136
    v_xor_b32 v81, s73, v137
    v_xor_b32 v82, s74, v138
    v_xor_b32 v83, s75, v139
    v_or3_b32 v80, v80, v81, v82
    v_or_b32 v80, v80, v83
    v_and_b32 v80, 0xfff, v80
    v_cmp_ne_u32 s[56:57], 0, v80
    v_xor_b32 v84, s72, v140
    v_xor_b32 v85, s73, v141
    v_xor_b32 v86, s74, v142
    v_xor_b32 v87, s75, v143
    v_or3_b32 v84, v84, v85, v86
    v_or_b32 v84, v84, v87
    v_and_b32 v84, 0xfff, v84
    v_cmp_ne_u32 s[58:59], 0, v84
    s_sub_u32 s85, s85, 1
    s_cmp_eq_u32 s85, 0
    s_cbranch_scc1 L_h2_ok
    s_or_b64 s[88:89], s[52:53], s[54:55]
    s_or_b64 s[82:83], s[56:57], s[58:59]
    s_or_b64 s[88:89], s[88:89], s[82:83]
    s_cbranch_scc1 L_h2
L_h2_ok:
    v_and_b32 v128, s76, v128
    v_and_b32 v129, s76, v129
    v_and_b32 v130, s76, v130
    v_and_b32 v131, s76, v131
    v_and_b32 v132, s76, v132
    v_and_b32 v133, s76, v133
    v_and_b32 v134, s76, v134
    v_and_b32 v135, s76, v135
    v_and_b32 v136, s76, v136
    v_and_b32 v137, s76, v137
    v_and_b32 v138, s76, v138
    v_and_b32 v139, s76, v139
    v_and_b32 v140, s76, v140
    v_and_b32 v141, s76, v141
    v_and_b32 v142, s76, v142
    v_and_b32 v143, s76, v143
    v_add_f32 v24, v128, v132
    v_add_f32 v32, v136, v140
    v_add_f32 v25, v129, v133
    v_add_f32 v33, v137, v141
    v_add_f32 v26, v130, v134
    v_add_f32 v34, v138, v142
    v_add_f32 v27, v131, v135
    v_add_f32 v35, v139, v143
    s_nop 1
    v_add_f32_dpp v24, v24, v24 row_ror:4 row_mask:0xf bank_mask:0xf
    v_add_f32_dpp v25, v25, v25 row_ror:4 row_mask:0xf bank_mask:0xf
    v_add_f32_dpp v26, v26, v26 row_ror:4 row_mask:0xf bank_mask:0xf
    v_add_f32_dpp v27, v27, v27 row_ror:4 row_mask:0xf bank_mask:0xf
    v_add_f32_dpp v32, v32, v32 row_ror:4 row_mask:0xf bank_mask:0xf
    v_add_f32_dpp v33, v33, v33 row_ror:4 row_mask:0xf bank_mask:0xf
    v_add_f32_dpp v34, v34, v34 row_ror:4 row_mask:0xf bank_mask:0xf
    v_add_f32_dpp v35, v35, v35 row_ror:4 row_mask:0xf bank_mask:0xf
    v_add_f32_dpp v24, v24, v24 row_ror:8 row_mask:0xf bank_mask:0xf
    v_add_f32_dpp v25, v25, v25 row_ror:8 row_mask:0xf bank_mask:0xf
    v_add_f32_dpp v26, v26, v26 row_ror:8 row_mask:0xf bank_mask:0xf
    v_add_f32_dpp v27, v27, v27 row_ror:8 row_mask:0xf bank_mask:0xf
    v_add_f32_dpp v32, v32, v32 row_ror:8 row_mask:0xf bank_mask:0xf
    v_add_f32_dpp v33, v33, v33 row_ror:8 row_mask:0xf bank_mask:0xf
    v_add_f32_dpp v34, v34, v34 row_ror:8 row_mask:0xf bank_mask:0xf
    v_add_f32_dpp v35, v35, v35 row_ror:8 row_mask:0xf bank_mask:0xf
    v_mov_b32 v36, v24
    v_mov_b32 v37, v25
    v_mov_b32 v38, v26
    v_mov_b32 v39, v27
    v_mov_b32 v44, v32
    v_mov_b32 v45, v33
    v_mov_b32 v46, v34
    v_mov_b32 v47, v35
    s_nop 1
    v_permlane16_swap_b32 v24, v36
    v_permlane16_swap_b32 v25, v37
    v_permlane16_swap_b32 v26, v38
    v_permlane16_swap_b32 v27, v39
    v_permlane16_swap_b32 v32, v44
    v_permlane16_swap_b32 v33, v45
    v_permlane16_swap_b32 v34, v46
    v_permlane16_swap_b32 v35, v47
    v_add_f32 v24, v24, v36
    v_add_f32 v25, v25, v37
    v_add_f32 v26, v26, v38
    v_add_f32 v27, v27, v39
    v_add_f32 v32, v32, v44
    v_add_f32 v33, v33, v45
    v_add_f32 v34, v34, v46
    v_add_f32 v35, v35, v47
    v_mov_b32 v36, v24
    v_mov_b32 v37, v25
    v_mov_b32 v38, v26
    v_mov_b32 v39, v27
    v_mov_b32 v44, v32
    v_mov_b32 v45, v33
    v_mov_b32 v46, v34
    v_mov_b32 v47, v35
    s_nop 1
    v_permlane32_swap_b32 v24, v36
    v_permlane32_swap_b32 v25, v37
    v_permlane32_swap_b32 v26, v38
    v_permlane32_swap_b32 v27, v39
    v_permlane32_swap_b32 v32, v44
    v_permlane32_swap_b32 v33, v45
    v_permlane32_swap_b32 v34, v46
    v_permlane32_swap_b32 v35, v47
    v_add_f32 v24, v24, v36
    v_add_f32 v25, v25, v37
    v_add_f32 v26, v26, v38
    v_add_f32 v27, v27, v39
    v_add_f32 v32, v32, v44
    v_add_f32 v33, v33, v45
    v_add_f32 v34, v34, v46
    v_add_f32 v35, v35, v47
    s_mov_b32 s88, 0xffff0000
    s_waitcnt lgkmcnt(0)
    v_sub_f32 v54, 1.0, v53
    v_cvt_pk_bf16_f32 v54, v54, v54
    v_and_b32 v54, s88, v54
    v_cvt_pk_bf16_f32 v56, v24, v25
    v_lshlrev_b32 v24, 16, v56
    v_and_b32 v25, s88, v56
    v_cvt_pk_bf16_f32 v57, v26, v27
    v_lshlrev_b32 v26, 16, v57
    v_and_b32 v27, s88, v57
    v_cvt_pk_bf16_f32 v58, v32, v33
    v_lshlrev_b32 v32, 16, v58
    v_and_b32 v33, s88, v58
    v_cvt_pk_bf16_f32 v59, v34, v35
    v_lshlrev_b32 v34, 16, v59
    v_and_b32 v35, s88, v59
    v_mul_f32 v24, v53, v24
    v_mul_f32 v32, v54, v32
    v_mul_f32 v25, v53, v25
    v_mul_f32 v33, v54, v33
    v_mul_f32 v26, v53, v26
    v_mul_f32 v34, v54, v34
    v_mul_f32 v27, v53, v27
    v_mul_f32 v35, v54, v35
    v_cvt_pk_bf16_f32 v56, v24, v25
    v_lshlrev_b32 v24, 16, v56
    v_and_b32 v25, s88, v56
    v_cvt_pk_bf16_f32 v57, v26, v27
    v_lshlrev_b32 v26, 16, v57
    v_and_b32 v27, s88, v57
    v_cvt_pk_bf16_f32 v58, v32, v33
    v_lshlrev_b32 v32, 16, v58
    v_and_b32 v33, s88, v58
    v_cvt_pk_bf16_f32 v59, v34, v35
    v_lshlrev_b32 v34, 16, v59
    v_and_b32 v35, s88, v59
    v_add_f32 v24, v24, v32
    v_add_f32 v25, v25, v33
    v_add_f32 v26, v26, v34
    v_add_f32 v27, v27, v35
    v_cvt_pk_bf16_f32 v24, v24, v25
    v_cvt_pk_bf16_f32 v25, v26, v27
    s_mov_b32 s72, s36
    s_and_b32 s73, s37, 0xffff
    s_mov_b32 s74, 8192
    s_mov_b32 s75, 0x20000
    s_lshl_b32 s86, s2, 5
    v_lshlrev_b32 v50, 3, v0
    s_mov_b64 exec, 0xf
    buffer_store_dwordx2 v[24:25], v50, s[72:75], s86 offen
    s_mov_b64 exec, -1
L_fin:
    s_endpgm
L_r2_2:
    s_nop 1
    s_waitcnt vmcnt(15)
    v_mfma_f32_16x16x32_bf16 v[18:21], v[160:163], v[14:17], 0
    s_nop 0
    s_nop 0
    s_nop 0
    s_nop 0
    s_waitcnt vmcnt(14)
    v_mfma_f32_16x16x32_bf16 v[22:25], v[164:167], v[14:17], 0
    s_nop 0
    s_nop 0
    s_nop 0
    s_nop 0
    s_waitcnt vmcnt(13)
    v_mfma_f32_16x16x32_bf16 v[26:29], v[168:171], v[14:17], 0
    v_mov_b32_dpp v34, v18 quad_perm:[0,1,2,3] row_mask:0xf bank_mask:1
    s_nop 0
    s_nop 0
    s_nop 0
    s_waitcnt vmcnt(12)
    v_mfma_f32_16x16x32_bf16 v[30:33], v[172:175], v[14:17], 0
    v_mov_b32_dpp v35, v22 quad_perm:[0,1,2,3] row_mask:0xf bank_mask:1
    v_add_f32_dpp v34, v19, v34 row_ror:12 row_mask:0xf bank_mask:1
    s_nop 0
    s_nop 0
    s_waitcnt vmcnt(11)
    v_mfma_f32_16x16x32_bf16 v[50:53], v[176:179], v[14:17], 0
    v_mov_b32_dpp v36, v26 quad_perm:[0,1,2,3] row_mask:0xf bank_mask:1
    v_add_f32_dpp v35, v23, v35 row_ror:12 row_mask:0xf bank_mask:1
    v_add_f32_dpp v34, v20, v34 row_ror:8 row_mask:0xf bank_mask:1
    s_nop 0
    s_waitcnt vmcnt(10)
    v_mfma_f32_16x16x32_bf16 v[54:57], v[180:183], v[14:17], 0
    v_mov_b32_dpp v37, v30 quad_perm:[0,1,2,3] row_mask:0xf bank_mask:1
    v_add_f32_dpp v36, v27, v36 row_ror:12 row_mask:0xf bank_mask:1
    v_add_f32_dpp v35, v24, v35 row_ror:8 row_mask:0xf bank_mask:1
    v_add_f32_dpp v34, v21, v34 row_ror:4 row_mask:0xf bank_mask:1
    s_waitcnt vmcnt(9)
    v_mfma_f32_16x16x32_bf16 v[18:21], v[184:187], v[14:17], 0
    v_mov_b32_dpp v38, v50 quad_perm:[0,1,2,3] row_mask:0xf bank_mask:1
    v_add_f32_dpp v37, v31, v37 row_ror:12 row_mask:0xf bank_mask:1
    v_add_f32_dpp v36, v28, v36 row_ror:8 row_mask:0xf bank_mask:1
    v_add_f32_dpp v35, v25, v35 row_ror:4 row_mask:0xf bank_mask:1
    s_waitcnt vmcnt(8)
    v_mfma_f32_16x16x32_bf16 v[22:25], v[188:191], v[14:17], 0
    v_mov_b32_dpp v39, v54 quad_perm:[0,1,2,3] row_mask:0xf bank_mask:1
    v_add_f32_dpp v38, v51, v38 row_ror:12 row_mask:0xf bank_mask:1
    v_add_f32_dpp v37, v32, v37 row_ror:8 row_mask:0xf bank_mask:1
    v_add_f32_dpp v36, v29, v36 row_ror:4 row_mask:0xf bank_mask:1
    s_nop 0
    v_mov_b32_dpp v40, v18 quad_perm:[0,1,2,3] row_mask:0xf bank_mask:1
    v_add_f32_dpp v39, v55, v39 row_ror:12 row_mask:0xf bank_mask:1
    v_add_f32_dpp v38, v52, v38 row_ror:8 row_mask:0xf bank_mask:1
    v_add_f32_dpp v37, v33, v37 row_ror:4 row_mask:0xf bank_mask:1
    s_nop 0
    v_mov_b32_dpp v41, v22 quad_perm:[0,1,2,3] row_mask:0xf bank_mask:1
    v_add_f32_dpp v40, v19, v40 row_ror:12 row_mask:0xf bank_mask:1
    v_add_f32_dpp v39, v56, v39 row_ror:8 row_mask:0xf bank_mask:1
    v_add_f32_dpp v38, v53, v38 row_ror:4 row_mask:0xf bank_mask:1
    s_nop 0
    s_nop 0
    v_add_f32_dpp v41, v23, v41 row_ror:12 row_mask:0xf bank_mask:1
    v_add_f32_dpp v40, v20, v40 row_ror:8 row_mask:0xf bank_mask:1
    v_add_f32_dpp v39, v57, v39 row_ror:4 row_mask:0xf bank_mask:1
    s_nop 0
    s_nop 0
    s_nop 0
    v_add_f32_dpp v41, v24, v41 row_ror:8 row_mask:0xf bank_mask:1
    v_add_f32_dpp v40, v21, v40 row_ror:4 row_mask:0xf bank_mask:1
    s_nop 0
    s_nop 0
    s_nop 0
    s_nop 0
    v_add_f32_dpp v41, v25, v41 row_ror:4 row_mask:0xf bank_mask:1
    s_nop 0
    s_nop 0
    s_nop 0
    s_nop 0
    s_nop 0
    s_mov_b32 s86, 1035273459
    s_mov_b32 s87, 1069066811
    s_mov_b32 s88, 0xffff0000
    v_cvt_pk_bf16_f32 v50, v34, v35
    v_lshlrev_b32 v34, 16, v50
    v_and_b32 v35, s88, v50
    v_mul_f32 v34, s86, v34
    v_mul_f32 v35, s86, v35
    v_cvt_pk_bf16_f32 v50, v34, v35
    v_lshlrev_b32 v34, 16, v50
    v_and_b32 v35, s88, v50
    v_cvt_pk_bf16_f32 v51, v36, v37
    v_lshlrev_b32 v36, 16, v51
    v_and_b32 v37, s88, v51
    v_mul_f32 v36, s86, v36
    v_mul_f32 v37, s86, v37
    v_cvt_pk_bf16_f32 v51, v36, v37
    v_lshlrev_b32 v36, 16, v51
    v_and_b32 v37, s88, v51
    v_cvt_pk_bf16_f32 v52, v38, v39
    v_lshlrev_b32 v38, 16, v52
    v_and_b32 v39, s88, v52
    v_mul_f32 v38, s86, v38
    v_mul_f32 v39, s86, v39
    v_cvt_pk_bf16_f32 v52, v38, v39
    v_lshlrev_b32 v38, 16, v52
    v_and_b32 v39, s88, v52
    v_cvt_pk_bf16_f32 v53, v40, v41
    v_lshlrev_b32 v40, 16, v53
    v_and_b32 v41, s88, v53
    v_mul_f32 v40, s86, v40
    v_mul_f32 v41, s86, v41
    v_cvt_pk_bf16_f32 v53, v40, v41
    v_lshlrev_b32 v40, 16, v53
    v_and_b32 v41, s88, v53
    v_max3_f32 v50, v34, v35, v36
    v_max3_f32 v50, v50, v37, v60
    v_max3_f32 v51, v38, v39, v40
    v_max3_f32 v50, v50, v51, v41
    s_nop 1
    v_max_f32_dpp v50, v50, v50 row_ror:4 row_mask:0xf bank_mask:0xf
    s_nop 1
    v_max_f32_dpp v50, v50, v50 row_ror:8 row_mask:0xf bank_mask:0xf
    v_mov_b32 v51, v50
    s_nop 1
    v_permlane16_swap_b32 v50, v51
    v_max_f32 v50, v50, v51
    v_mov_b32 v51, v50
    s_nop 1
    v_permlane32_swap_b32 v50, v51
    v_max_f32 v50, v50, v51
    v_sub_f32 v53, v60, v50
    v_mul_f32 v53, s87, v53
    v_exp_f32 v53, v53
    v_mul_f32 v52, s87, v50
    v_sub_f32 v52, 0, v52
    v_fma_f32 v34, v34, s87, v52
    v_fma_f32 v35, v35, s87, v52
    v_fma_f32 v36, v36, s87, v52
    v_fma_f32 v37, v37, s87, v52
    v_fma_f32 v38, v38, s87, v52
    v_fma_f32 v39, v39, s87, v52
    v_fma_f32 v40, v40, s87, v52
    v_fma_f32 v41, v41, s87, v52
    v_exp_f32 v34, v34
    v_exp_f32 v35, v35
    v_exp_f32 v36, v36
    v_exp_f32 v37, v37
    v_exp_f32 v38, v38
    v_exp_f32 v39, v39
    v_exp_f32 v40, v40
    v_exp_f32 v41, v41
    v_mul_f32 v51, v61, v53
    v_mul_f32 v64, v64, v53
    v_mul_f32 v65, v65, v53
    v_mul_f32 v66, v66, v53
    v_mul_f32 v67, v67, v53
    v_mul_f32 v68, v68, v53
    v_mul_f32 v69, v69, v53
    v_mul_f32 v70, v70, v53
    v_mul_f32 v71, v71, v53
    v_mul_f32 v72, v72, v53
    v_mul_f32 v73, v73, v53
    v_mul_f32 v74, v74, v53
    v_mul_f32 v75, v75, v53
    v_mul_f32 v76, v76, v53
    v_mul_f32 v77, v77, v53
    v_mul_f32 v78, v78, v53
    v_mul_f32 v79, v79, v53
    v_mul_f32 v80, v80, v53
    v_mul_f32 v81, v81, v53
    v_mul_f32 v82, v82, v53
    v_mul_f32 v83, v83, v53
    v_mul_f32 v84, v84, v53
    v_mul_f32 v85, v85, v53
    v_mul_f32 v86, v86, v53
    v_mul_f32 v87, v87, v53
    v_mul_f32 v88, v88, v53
    v_mul_f32 v89, v89, v53
    v_mul_f32 v90, v90, v53
    v_mul_f32 v91, v91, v53
    v_mul_f32 v92, v92, v53
    v_mul_f32 v93, v93, v53
    v_mul_f32 v94, v94, v53
    v_mul_f32 v95, v95, v53
    v_cvt_pk_bf16_f32 v18, v34, v35
    v_cvt_pk_bf16_f32 v19, v36, v37
    v_cvt_pk_bf16_f32 v20, v38, v39
    v_cvt_pk_bf16_f32 v21, v40, v41
    v_add_f32 v51, v51, v34
    v_add_f32 v51, v51, v35
    v_add_f32 v51, v51, v36
    v_add_f32 v51, v51, v37
    v_add_f32 v51, v51, v38
    v_add_f32 v51, v51, v39
    v_add_f32 v51, v51, v40
    v_add_f32 v51, v51, v41
    s_nop 1
    v_add_f32_dpp v51, v51, v51 row_ror:4 row_mask:0xf bank_mask:0xf
    s_nop 1
    v_add_f32_dpp v51, v51, v51 row_ror:8 row_mask:0xf bank_mask:0xf
    v_mov_b32 v53, v51
    s_nop 1
    v_permlane16_swap_b32 v51, v53
    v_add_f32 v51, v51, v53
    v_mov_b32 v53, v51
    s_nop 1
    v_permlane32_swap_b32 v51, v53
    v_add_f32 v51, v51, v53
    s_mov_b32 s69, 2
    s_branch L_stats
L_stats_ret_2:
    s_waitcnt vmcnt(4)
    ds_read_b64_tr_b16 v[96:97], v6 offset:0
    ds_read_b64_tr_b16 v[100:101], v7 offset:0
    ds_read_b64_tr_b16 v[104:105], v8 offset:0
    ds_read_b64_tr_b16 v[108:109], v9 offset:0
    ds_read_b64_tr_b16 v[112:113], v10 offset:0
    ds_read_b64_tr_b16 v[116:117], v11 offset:0
    ds_read_b64_tr_b16 v[120:121], v12 offset:0
    ds_read_b64_tr_b16 v[124:125], v13 offset:0
    s_waitcnt vmcnt(0)
    ds_read_b64_tr_b16 v[98:99], v6 offset:4096
    ds_read_b64_tr_b16 v[102:103], v7 offset:4096
    ds_read_b64_tr_b16 v[106:107], v8 offset:4096
    ds_read_b64_tr_b16 v[110:111], v9 offset:4096
    ds_read_b64_tr_b16 v[114:115], v10 offset:4096
    ds_read_b64_tr_b16 v[118:119], v11 offset:4096
    ds_read_b64_tr_b16 v[122:123], v12 offset:4096
    ds_read_b64_tr_b16 v[126:127], v13 offset:4096
    s_waitcnt lgkmcnt(7)
    v_mfma_f32_16x16x32_bf16 v[64:67], v[96:99], v[18:21], v[64:67]
    s_waitcnt lgkmcnt(6)
    v_mfma_f32_16x16x32_bf16 v[68:71], v[100:103], v[18:21], v[68:71]
    s_waitcnt lgkmcnt(5)
    v_mfma_f32_16x16x32_bf16 v[72:75], v[104:107], v[18:21], v[72:75]
    s_waitcnt lgkmcnt(4)
    v_mfma_f32_16x16x32_bf16 v[76:79], v[108:111], v[18:21], v[76:79]
    s_waitcnt lgkmcnt(3)
    v_mfma_f32_16x16x32_bf16 v[80:83], v[112:115], v[18:21], v[80:83]
    s_waitcnt lgkmcnt(2)
    v_mfma_f32_16x16x32_bf16 v[84:87], v[116:119], v[18:21], v[84:87]
    s_waitcnt lgkmcnt(1)
    v_mfma_f32_16x16x32_bf16 v[88:91], v[120:123], v[18:21], v[88:91]
    s_waitcnt lgkmcnt(0)
    v_mfma_f32_16x16x32_bf16 v[92:95], v[124:127], v[18:21], v[92:95]
    s_branch L_vdone
L_r2_3:
    s_nop 1
    s_waitcnt vmcnt(3)
    s_mov_b32 s83, s76
    buffer_load_dwordx4 v[192:195], v1, s[4:7], s83 offen offset:0 nt
    s_waitcnt vmcnt(3)
    s_cmp_gt_u32 s75, 1
    s_cselect_b32 s83, s83, s59
    buffer_load_dwordx4 v[196:199], v1, s[4:7], s83 offen offset:1024 nt
    s_waitcnt vmcnt(17)
    v_mfma_f32_16x16x32_bf16 v[18:21], v[160:163], v[14:17], 0
    s_nop 0
    s_nop 0
    s_nop 0
    s_nop 0
    s_waitcnt vmcnt(3)
    s_cmp_gt_u32 s75, 2
    s_cselect_b32 s83, s83, s59
    buffer_load_dwordx4 v[200:203], v1, s[4:7], s83 offen offset:2048 nt
    s_waitcnt vmcnt(3)
    s_cmp_gt_u32 s75, 3
    s_cselect_b32 s83, s83, s59
    buffer_load_dwordx4 v[204:207], v1, s[4:7], s83 offen offset:3072 nt
    s_waitcnt vmcnt(18)
    v_mfma_f32_16x16x32_bf16 v[22:25], v[164:167], v[14:17], 0
    s_nop 0
    s_nop 0
    s_nop 0
    s_nop 0
    s_waitcnt vmcnt(3)
    s_mov_b32 s84, s76
    s_add_u32 m0, s80, 8192
    s_nop 0
    buffer_load_dwordx4 v2, s[8:11], s84 offen offset:0 nt lds
    s_waitcnt vmcnt(3)
    s_cmp_gt_u32 s75, 1
    s_cselect_b32 s84, s84, s59
    buffer_load_dwordx4 v3, s[8:11], s84 offen offset:1024 nt lds
    s_waitcnt vmcnt(19)
    v_mfma_f32_16x16x32_bf16 v[26:29], v[168:171], v[14:17], 0
    v_mov_b32_dpp v34, v18 quad_perm:[0,1,2,3] row_mask:0xf bank_mask:1
    s_nop 0
    s_nop 0
    s_nop 0
    s_waitcnt vmcnt(3)
    s_cmp_gt_u32 s75, 2
    s_cselect_b32 s84, s84, s59
    buffer_load_dwordx4 v4, s[8:11], s84 offen offset:2048 nt lds
    s_waitcnt vmcnt(3)
    s_cmp_gt_u32 s75, 3
    s_cselect_b32 s84, s84, s59
    buffer_load_dwordx4 v5, s[8:11], s84 offen offset:3072 nt lds
    s_waitcnt vmcnt(20)
    v_mfma_f32_16x16x32_bf16 v[30:33], v[172:175], v[14:17], 0
    v_mov_b32_dpp v35, v22 quad_perm:[0,1,2,3] row_mask:0xf bank_mask:1
    v_add_f32_dpp v34, v19, v34 row_ror:12 row_mask:0xf bank_mask:1
    s_nop 0
    s_nop 0
    s_waitcnt vmcnt(19)
    v_mfma_f32_16x16x32_bf16 v[50:53], v[176:179], v[14:17], 0
    v_mov_b32_dpp v36, v26 quad_perm:[0,1,2,3] row_mask:0xf bank_mask:1
    v_add_f32_dpp v35, v23, v35 row_ror:12 row_mask:0xf bank_mask:1
    v_add_f32_dpp v34, v20, v34 row_ror:8 row_mask:0xf bank_mask:1
    s_nop 0
    s_waitcnt vmcnt(18)
    v_mfma_f32_16x16x32_bf16 v[54:57], v[180:183], v[14:17], 0
    v_mov_b32_dpp v37, v30 quad_perm:[0,1,2,3] row_mask:0xf bank_mask:1
    v_add_f32_dpp v36, v27, v36 row_ror:12 row_mask:0xf bank_mask:1
    v_add_f32_dpp v35, v24, v35 row_ror:8 row_mask:0xf bank_mask:1
    v_add_f32_dpp v34, v21, v34 row_ror:4 row_mask:0xf bank_mask:1
    s_waitcnt vmcnt(17)
    v_mfma_f32_16x16x32_bf16 v[18:21], v[184:187], v[14:17], 0
    v_mov_b32_dpp v38, v50 quad_perm:[0,1,2,3] row_mask:0xf bank_mask:1
    v_add_f32_dpp v37, v31, v37 row_ror:12 row_mask:0xf bank_mask:1
    v_add_f32_dpp v36, v28, v36 row_ror:8 row_mask:0xf bank_mask:1
    v_add_f32_dpp v35, v25, v35 row_ror:4 row_mask:0xf bank_mask:1
    s_waitcnt vmcnt(16)
    v_mfma_f32_16x16x32_bf16 v[22:25], v[188:191], v[14:17], 0
    v_mov_b32_dpp v39, v54 quad_perm:[0,1,2,3] row_mask:0xf bank_mask:1
    v_add_f32_dpp v38, v51, v38 row_ror:12 row_mask:0xf bank_mask:1
    v_add_f32_dpp v37, v32, v37 row_ror:8 row_mask:0xf bank_mask:1
    v_add_f32_dpp v36, v29, v36 row_ror:4 row_mask:0xf bank_mask:1
    s_waitcnt vmcnt(7)
    v_mfma_f32_16x16x32_bf16 v[26:29], v[192:195], v[14:17], 0
    v_mov_b32_dpp v40, v18 quad_perm:[0,1,2,3] row_mask:0xf bank_mask:1
    v_add_f32_dpp v39, v55, v39 row_ror:12 row_mask:0xf bank_mask:1
    v_add_f32_dpp v38, v52, v38 row_ror:8 row_mask:0xf bank_mask:1
    v_add_f32_dpp v37, v33, v37 row_ror:4 row_mask:0xf bank_mask:1
    s_waitcnt vmcnt(6)
    v_mfma_f32_16x16x32_bf16 v[30:33], v[196:199], v[14:17], 0
    v_mov_b32_dpp v41, v22 quad_perm:[0,1,2,3] row_mask:0xf bank_mask:1
    v_add_f32_dpp v40, v19, v40 row_ror:12 row_mask:0xf bank_mask:1
    v_add_f32_dpp v39, v56, v39 row_ror:8 row_mask:0xf bank_mask:1
    v_add_f32_dpp v38, v53, v38 row_ror:4 row_mask:0xf bank_mask:1
    s_waitcnt vmcnt(5)
    v_mfma_f32_16x16x32_bf16 v[50:53], v[200:203], v[14:17], 0
    v_mov_b32_dpp v34, v27 quad_perm:[0,1,2,3] row_mask:0xf bank_mask:2
    v_add_f32_dpp v41, v23, v41 row_ror:12 row_mask:0xf bank_mask:1
    v_add_f32_dpp v40, v20, v40 row_ror:8 row_mask:0xf bank_mask:1
    v_add_f32_dpp v39, v57, v39 row_ror:4 row_mask:0xf bank_mask:1
    s_waitcnt vmcnt(4)
    v_mfma_f32_16x16x32_bf16 v[54:57], v[204:207], v[14:17], 0
    v_mov_b32_dpp v35, v31 quad_perm:[0,1,2,3] row_mask:0xf bank_mask:2
    v_add_f32_dpp v34, v28, v34 row_ror:12 row_mask:0xf bank_mask:2
    v_add_f32_dpp v41, v24, v41 row_ror:8 row_mask:0xf bank_mask:1
    v_add_f32_dpp v40, v21, v40 row_ror:4 row_mask:0xf bank_mask:1
    s_nop 0
    v_mov_b32_dpp v36, v51 quad_perm:[0,1,2,3] row_mask:0xf bank_mask:2
    v_add_f32_dpp v35, v32, v35 row_ror:12 row_mask:0xf bank_mask:2
    v_add_f32_dpp v34, v29, v34 row_ror:8 row_mask:0xf bank_mask:2
    v_add_f32_dpp v41, v25, v41 row_ror:4 row_mask:0xf bank_mask:1
    s_nop 0
    v_mov_b32_dpp v37, v55 quad_perm:[0,1,2,3] row_mask:0xf bank_mask:2
    v_add_f32_dpp v36, v52, v36 row_ror:12 row_mask:0xf bank_mask:2
    v_add_f32_dpp v35, v33, v35 row_ror:8 row_mask:0xf bank_mask:2
    v_add_f32_dpp v34, v26, v34 row_ror:4 row_mask:0xf bank_mask:2
    s_nop 0
    s_nop 0
    v_add_f32_dpp v37, v56, v37 row_ror:12 row_mask:0xf bank_mask:2
    v_add_f32_dpp v36, v53, v36 row_ror:8 row_mask:0xf bank_mask:2
    v_add_f32_dpp v35, v30, v35 row_ror:4 row_mask:0xf bank_mask:2
    s_nop 0
    s_nop 0
    s_nop 0
    v_add_f32_dpp v37, v57, v37 row_ror:8 row_mask:0xf bank_mask:2
    v_add_f32_dpp v36, v50, v36 row_ror:4 row_mask:0xf bank_mask:2
    s_nop 0
    s_nop 0
    s_nop 0
    s_nop 0
    v_add_f32_dpp v37, v54, v37 row_ror:4 row_mask:0xf bank_mask:2
    s_nop 0
    s_nop 0
    s_nop 0
    s_nop 0
    s_nop 0
    v_mov_b32 v50, 0xff7fffff
    s_cmp_gt_u32 s75, 1
    s_cselect_b32 s86, 0, 0xf000f0
    s_cselect_b32 s87, 0, 0xf000f0
    v_cndmask_b32 v35, v35, v50, s[86:87]
    s_cmp_gt_u32 s75, 2
    s_cselect_b32 s86, 0, 0xf000f0
    s_cselect_b32 s87, 0, 0xf000f0
    v_cndmask_b32 v36, v36, v50, s[86:87]
    s_cmp_gt_u32 s75, 3
    s_cselect_b32 s86, 0, 0xf000f0
    s_cselect_b32 s87, 0, 0xf000f0
    v_cndmask_b32 v37, v37, v50, s[86:87]
    s_mov_b32 s86, 1035273459
    s_mov_b32 s87, 1069066811
    s_mov_b32 s88, 0xffff0000
    v_cvt_pk_bf16_f32 v50, v34, v35
    v_lshlrev_b32 v34, 16, v50
    v_and_b32 v35, s88, v50
    v_mul_f32 v34, s86, v34
    v_mul_f32 v35, s86, v35
    v_cvt_pk_bf16_f32 v50, v34, v35
    v_lshlrev_b32 v34, 16, v50
    v_and_b32 v35, s88, v50
    v_cvt_pk_bf16_f32 v51, v36, v37
    v_lshlrev_b32 v36, 16, v51
    v_and_b32 v37, s88, v51
    v_mul_f32 v36, s86, v36
    v_mul_f32 v37, s86, v37
    v_cvt_pk_bf16_f32 v51, v36, v37
    v_lshlrev_b32 v36, 16, v51
    v_and_b32 v37, s88, v51
    v_cvt_pk_bf16_f32 v52, v38, v39
    v_lshlrev_b32 v38, 16, v52
    v_and_b32 v39, s88, v52
    v_mul_f32 v38, s86, v38
    v_mul_f32 v39, s86, v39
    v_cvt_pk_bf16_f32 v52, v38, v39
    v_lshlrev_b32 v38, 16, v52
    v_and_b32 v39, s88, v52
    v_cvt_pk_bf16_f32 v53, v40, v41
    v_lshlrev_b32 v40, 16, v53
    v_and_b32 v41, s88, v53
    v_mul_f32 v40, s86, v40
    v_mul_f32 v41, s86, v41
    v_cvt_pk_bf16_f32 v53, v40, v41
    v_lshlrev_b32 v40, 16, v53
    v_and_b32 v41, s88, v53
    v_max3_f32 v50, v34, v35, v36
    v_max3_f32 v50, v50, v37, v60
    v_max3_f32 v51, v38, v39, v40
    v_max3_f32 v50, v50, v51, v41
    s_nop 1
    v_max_f32_dpp v50, v50, v50 row_ror:4 row_mask:0xf bank_mask:0xf
    s_nop 1
    v_max_f32_dpp v50, v50, v50 row_ror:8 row_mask:0xf bank_mask:0xf
    v_mov_b32 v51, v50
    s_nop 1
    v_permlane16_swap_b32 v50, v51
    v_max_f32 v50, v50, v51
    v_mov_b32 v51, v50
    s_nop 1
    v_permlane32_swap_b32 v50, v51
    v_max_f32 v50, v50, v51
    v_sub_f32 v53, v60, v50
    v_mul_f32 v53, s87, v53
    v_exp_f32 v53, v53
    v_mul_f32 v52, s87, v50
    v_sub_f32 v52, 0, v52
    v_fma_f32 v34, v34, s87, v52
    v_fma_f32 v35, v35, s87, v52
    v_fma_f32 v36, v36, s87, v52
    v_fma_f32 v37, v37, s87, v52
    v_fma_f32 v38, v38, s87, v52
    v_fma_f32 v39, v39, s87, v52
    v_fma_f32 v40, v40, s87, v52
    v_fma_f32 v41, v41, s87, v52
    v_exp_f32 v34, v34
    v_exp_f32 v35, v35
    v_exp_f32 v36, v36
    v_exp_f32 v37, v37
    v_exp_f32 v38, v38
    v_exp_f32 v39, v39
    v_exp_f32 v40, v40
    v_exp_f32 v41, v41
    v_mul_f32 v51, v61, v53
    v_mul_f32 v64, v64, v53
    v_mul_f32 v65, v65, v53
    v_mul_f32 v66, v66, v53
    v_mul_f32 v67, v67, v53
    v_mul_f32 v68, v68, v53
    v_mul_f32 v69, v69, v53
    v_mul_f32 v70, v70, v53
    v_mul_f32 v71, v71, v53
    v_mul_f32 v72, v72, v53
    v_mul_f32 v73, v73, v53
    v_mul_f32 v74, v74, v53
    v_mul_f32 v75, v75, v53
    v_mul_f32 v76, v76, v53
    v_mul_f32 v77, v77, v53
    v_mul_f32 v78, v78, v53
    v_mul_f32 v79, v79, v53
    v_mul_f32 v80, v80, v53
    v_mul_f32 v81, v81, v53
    v_mul_f32 v82, v82, v53
    v_mul_f32 v83, v83, v53
    v_mul_f32 v84, v84, v53
    v_mul_f32 v85, v85, v53
    v_mul_f32 v86, v86, v53
    v_mul_f32 v87, v87, v53
    v_mul_f32 v88, v88, v53
    v_mul_f32 v89, v89, v53
    v_mul_f32 v90, v90, v53
    v_mul_f32 v91, v91, v53
    v_mul_f32 v92, v92, v53
    v_mul_f32 v93, v93, v53
    v_mul_f32 v94, v94, v53
    v_mul_f32 v95, v95, v53
    v_cvt_pk_bf16_f32 v18, v34, v35
    v_cvt_pk_bf16_f32 v19, v36, v37
    v_cvt_pk_bf16_f32 v20, v38, v39
    v_cvt_pk_bf16_f32 v21, v40, v41
    v_add_f32 v51, v51, v34
    v_add_f32 v51, v51, v35
    v_add_f32 v51, v51, v36
    v_add_f32 v51, v51, v37
    v_add_f32 v51, v51, v38
    v_add_f32 v51, v51, v39
    v_add_f32 v51, v51, v40
    v_add_f32 v51, v51, v41
    s_nop 1
    v_add_f32_dpp v51, v51, v51 row_ror:4 row_mask:0xf bank_mask:0xf
    s_nop 1
    v_add_f32_dpp v51, v51, v51 row_ror:8 row_mask:0xf bank_mask:0xf
    v_mov_b32 v53, v51
    s_nop 1
    v_permlane16_swap_b32 v51, v53
    v_add_f32 v51, v51, v53
    v_mov_b32 v53, v51
    s_nop 1
    v_permlane32_swap_b32 v51, v53
    v_add_f32 v51, v51, v53
    s_mov_b32 s69, 3
    s_branch L_stats
L_stats_ret_3:
    ds_read_b64_tr_b16 v[96:97], v6 offset:0
    ds_read_b64_tr_b16 v[100:101], v7 offset:0
    ds_read_b64_tr_b16 v[104:105], v8 offset:0
    ds_read_b64_tr_b16 v[108:109], v9 offset:0
    ds_read_b64_tr_b16 v[112:113], v10 offset:0
    ds_read_b64_tr_b16 v[116:117], v11 offset:0
    ds_read_b64_tr_b16 v[120:121], v12 offset:0
    ds_read_b64_tr_b16 v[124:125], v13 offset:0
    ds_read_b64_tr_b16 v[98:99], v6 offset:4096
    ds_read_b64_tr_b16 v[102:103], v7 offset:4096
    ds_read_b64_tr_b16 v[106:107], v8 offset:4096
    ds_read_b64_tr_b16 v[110:111], v9 offset:4096
    ds_read_b64_tr_b16 v[114:115], v10 offset:4096
    ds_read_b64_tr_b16 v[118:119], v11 offset:4096
    ds_read_b64_tr_b16 v[122:123], v12 offset:4096
    ds_read_b64_tr_b16 v[126:127], v13 offset:4096
    s_waitcnt lgkmcnt(7)
    v_mfma_f32_16x16x32_bf16 v[64:67], v[96:99], v[18:21], v[64:67]
    s_waitcnt lgkmcnt(6)
    v_mfma_f32_16x16x32_bf16 v[68:71], v[100:103], v[18:21], v[68:71]
    s_waitcnt lgkmcnt(5)
    v_mfma_f32_16x16x32_bf16 v[72:75], v[104:107], v[18:21], v[72:75]
    s_waitcnt lgkmcnt(4)
    v_mfma_f32_16x16x32_bf16 v[76:79], v[108:111], v[18:21], v[76:79]
    s_waitcnt lgkmcnt(3)
    v_mfma_f32_16x16x32_bf16 v[80:83], v[112:115], v[18:21], v[80:83]
    s_waitcnt lgkmcnt(2)
    v_mfma_f32_16x16x32_bf16 v[84:87], v[116:119], v[18:21], v[84:87]
    s_waitcnt lgkmcnt(1)
    v_mfma_f32_16x16x32_bf16 v[88:91], v[120:123], v[18:21], v[88:91]
    s_waitcnt lgkmcnt(0)
    v_mfma_f32_16x16x32_bf16 v[92:95], v[124:127], v[18:21], v[92:95]
    v_mov_b32_dpp v30, v18 row_ror:12 row_mask:0xf bank_mask:0xf
    v_mov_b32_dpp v31, v19 row_ror:12 row_mask:0xf bank_mask:0xf
    v_mov_b32_dpp v32, v20 row_ror:12 row_mask:0xf bank_mask:0xf
    v_mov_b32_dpp v33, v21 row_ror:12 row_mask:0xf bank_mask:0xf
    s_waitcnt vmcnt(0)
    ds_read_b64_tr_b16 v[128:129], v6 offset:8192
    ds_read_b64_tr_b16 v[132:133], v7 offset:8192
    ds_read_b64_tr_b16 v[136:137], v8 offset:8192
    ds_read_b64_tr_b16 v[140:141], v9 offset:8192
    ds_read_b64_tr_b16 v[144:145], v10 offset:8192
    ds_read_b64_tr_b16 v[148:149], v11 offset:8192
    ds_read_b64_tr_b16 v[152:153], v12 offset:8192
    ds_read_b64_tr_b16 v[156:157], v13 offset:8192
    s_waitcnt lgkmcnt(7)
    v_mfma_f32_16x16x16_bf16 v[64:67], v[128:129], v[30:31], v[64:67]
    s_waitcnt lgkmcnt(6)
    v_mfma_f32_16x16x16_bf16 v[68:71], v[132:133], v[30:31], v[68:71]
    s_waitcnt lgkmcnt(5)
    v_mfma_f32_16x16x16_bf16 v[72:75], v[136:137], v[30:31], v[72:75]
    s_waitcnt lgkmcnt(4)
    v_mfma_f32_16x16x16_bf16 v[76:79], v[140:141], v[30:31], v[76:79]
    s_waitcnt lgkmcnt(3)
    v_mfma_f32_16x16x16_bf16 v[80:83], v[144:145], v[30:31], v[80:83]
    s_waitcnt lgkmcnt(2)
    v_mfma_f32_16x16x16_bf16 v[84:87], v[148:149], v[30:31], v[84:87]
    s_waitcnt lgkmcnt(1)
    v_mfma_f32_16x16x16_bf16 v[88:91], v[152:153], v[30:31], v[88:91]
    s_waitcnt lgkmcnt(0)
    v_mfma_f32_16x16x16_bf16 v[92:95], v[156:157], v[30:31], v[92:95]
    s_branch L_vdone
L_r2_4:
    s_nop 1
    s_waitcnt vmcnt(3)
    s_add_u32 s83, s77, 0
    buffer_load_dwordx4 v[192:195], v1, s[4:7], s83 offen offset:0 nt
    s_waitcnt vmcnt(3)
    buffer_load_dwordx4 v[196:199], v1, s[4:7], s83 offen offset:1024 nt
    s_waitcnt vmcnt(17)
    v_mfma_f32_16x16x32_bf16 v[18:21], v[160:163], v[14:17], 0
    s_nop 0
    s_nop 0
    s_nop 0
    s_nop 0
    s_waitcnt vmcnt(3)
    buffer_load_dwordx4 v[200:203], v1, s[4:7], s83 offen offset:2048 nt
    s_waitcnt vmcnt(3)
    buffer_load_dwordx4 v[204:207], v1, s[4:7], s83 offen offset:3072 nt
    s_waitcnt vmcnt(18)
    v_mfma_f32_16x16x32_bf16 v[22:25], v[164:167], v[14:17], 0
    s_nop 0
    s_nop 0
    s_nop 0
    s_nop 0
    s_waitcnt vmcnt(3)
    s_mov_b32 s83, s76
    buffer_load_dwordx4 v[208:211], v1, s[4:7], s83 offen offset:0 nt
    s_waitcnt vmcnt(3)
    s_cmp_gt_u32 s75, 1
    s_cselect_b32 s83, s83, s59
    buffer_load_dwordx4 v[212:215], v1, s[4:7], s83 offen offset:1024 nt
    s_waitcnt vmcnt(19)
    v_mfma_f32_16x16x32_bf16 v[26:29], v[168:171], v[14:17], 0
    v_mov_b32_dpp v34, v18 quad_perm:[0,1,2,3] row_mask:0xf bank_mask:1
    s_nop 0
    s_nop 0
    s_nop 0
    s_waitcnt vmcnt(3)
    s_cmp_gt_u32 s75, 2
    s_cselect_b32 s83, s83, s59
    buffer_load_dwordx4 v[216:219], v1, s[4:7], s83 offen offset:2048 nt
    s_waitcnt vmcnt(3)
    s_cmp_gt_u32 s75, 3
    s_cselect_b32 s83, s83, s59
    buffer_load_dwordx4 v[220:223], v1, s[4:7], s83 offen offset:3072 nt
    s_waitcnt vmcnt(20)
    v_mfma_f32_16x16x32_bf16 v[30:33], v[172:175], v[14:17], 0
    v_mov_b32_dpp v35, v22 quad_perm:[0,1,2,3] row_mask:0xf bank_mask:1
    v_add_f32_dpp v34, v19, v34 row_ror:12 row_mask:0xf bank_mask:1
    s_nop 0
    s_nop 0
    s_waitcnt vmcnt(3)
    s_add_u32 s84, s77, 0
    s_add_u32 m0, s80, 8192
    s_nop 0
    buffer_load_dwordx4 v2, s[8:11], s84 offen offset:0 nt lds
    s_waitcnt vmcnt(3)
    buffer_load_dwordx4 v3, s[8:11], s84 offen offset:1024 nt lds
    s_waitcnt vmcnt(21)
    v_mfma_f32_16x16x32_bf16 v[50:53], v[176:179], v[14:17], 0
    v_mov_b32_dpp v36, v26 quad_perm:[0,1,2,3] row_mask:0xf bank_mask:1
    v_add_f32_dpp v35, v23, v35 row_ror:12 row_mask:0xf bank_mask:1
    v_add_f32_dpp v34, v20, v34 row_ror:8 row_mask:0xf bank_mask:1
    s_nop 0
    s_waitcnt vmcnt(3)
    buffer_load_dwordx4 v4, s[8:11], s84 offen offset:2048 nt lds
    s_waitcnt vmcnt(3)
    buffer_load_dwordx4 v5, s[8:11], s84 offen offset:3072 nt lds
    s_waitcnt vmcnt(22)
    v_mfma_f32_16x16x32_bf16 v[54:57], v[180:183], v[14:17], 0
    v_mov_b32_dpp v37, v30 quad_perm:[0,1,2,3] row_mask:0xf bank_mask:1
    v_add_f32_dpp v36, v27, v36 row_ror:12 row_mask:0xf bank_mask:1
    v_add_f32_dpp v35, v24, v35 row_ror:8 row_mask:0xf bank_mask:1
    v_add_f32_dpp v34, v21, v34 row_ror:4 row_mask:0xf bank_mask:1
    s_waitcnt vmcnt(3)
    s_mov_b32 s84, s76
    s_add_u32 m0, s80, 12288
    s_nop 0
    buffer_load_dwordx4 v2, s[8:11], s84 offen offset:0 nt lds
    s_waitcnt vmcnt(3)
    s_cmp_gt_u32 s75, 1
    s_cselect_b32 s84, s84, s59
    buffer_load_dwordx4 v3, s[8:11], s84 offen offset:1024 nt lds
    s_waitcnt vmcnt(23)
    v_mfma_f32_16x16x32_bf16 v[18:21], v[184:187], v[14:17], 0
    v_mov_b32_dpp v38, v50 quad_perm:[0,1,2,3] row_mask:0xf bank_mask:1
    v_add_f32_dpp v37, v31, v37 row_ror:12 row_mask:0xf bank_mask:1
    v_add_f32_dpp v36, v28, v36 row_ror:8 row_mask:0xf bank_mask:1
    v_add_f32_dpp v35, v25, v35 row_ror:4 row_mask:0xf bank_mask:1
    s_waitcnt vmcnt(3)
    s_cmp_gt_u32 s75, 2
    s_cselect_b32 s84, s84, s59
    buffer_load_dwordx4 v4, s[8:11], s84 offen offset:2048 nt lds
    s_waitcnt vmcnt(3)
    s_cmp_gt_u32 s75, 3
    s_cselect_b32 s84, s84, s59
    buffer_load_dwordx4 v5, s[8:11], s84 offen offset:3072 nt lds
    s_waitcnt vmcnt(24)
    v_mfma_f32_16x16x32_bf16 v[22:25], v[188:191], v[14:17], 0
    v_mov_b32_dpp v39, v54 quad_perm:[0,1,2,3] row_mask:0xf bank_mask:1
    v_add_f32_dpp v38, v51, v38 row_ror:12 row_mask:0xf bank_mask:1
    v_add_f32_dpp v37, v32, v37 row_ror:8 row_mask:0xf bank_mask:1
    v_add_f32_dpp v36, v29, v36 row_ror:4 row_mask:0xf bank_mask:1
    s_waitcnt vmcnt(15)
    v_mfma_f32_16x16x32_bf16 v[26:29], v[192:195], v[14:17], 0
    v_mov_b32_dpp v40, v18 quad_perm:[0,1,2,3] row_mask:0xf bank_mask:1
    v_add_f32_dpp v39, v55, v39 row_ror:12 row_mask:0xf bank_mask:1
    v_add_f32_dpp v38, v52, v38 row_ror:8 row_mask:0xf bank_mask:1
    v_add_f32_dpp v37, v33, v37 row_ror:4 row_mask:0xf bank_mask:1
    s_waitcnt vmcnt(14)
    v_mfma_f32_16x16x32_bf16 v[30:33], v[196:199], v[14:17], 0
    v_mov_b32_dpp v41, v22 quad_perm:[0,1,2,3] row_mask:0xf bank_mask:1
    v_add_f32_dpp v40, v19, v40 row_ror:12 row_mask:0xf bank_mask:1
    v_add_f32_dpp v39, v56, v39 row_ror:8 row_mask:0xf bank_mask:1
    v_add_f32_dpp v38, v53, v38 row_ror:4 row_mask:0xf bank_mask:1
    s_waitcnt vmcnt(13)
    v_mfma_f32_16x16x32_bf16 v[50:53], v[200:203], v[14:17], 0
    v_mov_b32_dpp v34, v27 quad_perm:[0,1,2,3] row_mask:0xf bank_mask:2
    v_add_f32_dpp v41, v23, v41 row_ror:12 row_mask:0xf bank_mask:1
    v_add_f32_dpp v40, v20, v40 row_ror:8 row_mask:0xf bank_mask:1
    v_add_f32_dpp v39, v57, v39 row_ror:4 row_mask:0xf bank_mask:1
    s_waitcnt vmcnt(12)
    v_mfma_f32_16x16x32_bf16 v[54:57], v[204:207], v[14:17], 0
    v_mov_b32_dpp v35, v31 quad_perm:[0,1,2,3] row_mask:0xf bank_mask:2
    v_add_f32_dpp v34, v28, v34 row_ror:12 row_mask:0xf bank_mask:2
    v_add_f32_dpp v41, v24, v41 row_ror:8 row_mask:0xf bank_mask:1
    v_add_f32_dpp v40, v21, v40 row_ror:4 row_mask:0xf bank_mask:1
    s_waitcnt vmcnt(11)
    v_mfma_f32_16x16x32_bf16 v[18:21], v[208:211], v[14:17], 0
    v_mov_b32_dpp v36, v51 quad_perm:[0,1,2,3] row_mask:0xf bank_mask:2
    v_add_f32_dpp v35, v32, v35 row_ror:12 row_mask:0xf bank_mask:2
    v_add_f32_dpp v34, v29, v34 row_ror:8 row_mask:0xf bank_mask:2
    v_add_f32_dpp v41, v25, v41 row_ror:4 row_mask:0xf bank_mask:1
    s_waitcnt vmcnt(10)
    v_mfma_f32_16x16x32_bf16 v[22:25], v[212:215], v[14:17], 0
    v_mov_b32_dpp v37, v55 quad_perm:[0,1,2,3] row_mask:0xf bank_mask:2
    v_add_f32_dpp v36, v52, v36 row_ror:12 row_mask:0xf bank_mask:2
    v_add_f32_dpp v35, v33, v35 row_ror:8 row_mask:0xf bank_mask:2
    v_add_f32_dpp v34, v26, v34 row_ror:4 row_mask:0xf bank_mask:2
    s_waitcnt vmcnt(9)
    v_mfma_f32_16x16x32_bf16 v[26:29], v[216:219], v[14:17], 0
    v_mov_b32_dpp v38, v19 quad_perm:[0,1,2,3] row_mask:0xf bank_mask:2
    v_add_f32_dpp v37, v56, v37 row_ror:12 row_mask:0xf bank_mask:2
    v_add_f32_dpp v36, v53, v36 row_ror:8 row_mask:0xf bank_mask:2
    v_add_f32_dpp v35, v30, v35 row_ror:4 row_mask:0xf bank_mask:2
    s_waitcnt vmcnt(8)
    v_mfma_f32_16x16x32_bf16 v[30:33], v[220:223], v[14:17], 0
    v_mov_b32_dpp v39, v23 quad_perm:[0,1,2,3] row_mask:0xf bank_mask:2
    v_add_f32_dpp v38, v20, v38 row_ror:12 row_mask:0xf bank_mask:2
    v_add_f32_dpp v37, v57, v37 row_ror:8 row_mask:0xf bank_mask:2
    v_add_f32_dpp v36, v50, v36 row_ror:4 row_mask:0xf bank_mask:2
    s_nop 0
    v_mov_b32_dpp v40, v27 quad_perm:[0,1,2,3] row_mask:0xf bank_mask:2
    v_add_f32_dpp v39, v24, v39 row_ror:12 row_mask:0xf bank_mask:2
    v_add_f32_dpp v38, v21, v38 row_ror:8 row_mask:0xf bank_mask:2
    v_add_f32_dpp v37, v54, v37 row_ror:4 row_mask:0xf bank_mask:2
    s_nop 0
    v_mov_b32_dpp v41, v31 quad_perm:[0,1,2,3] row_mask:0xf bank_mask:2
    v_add_f32_dpp v40, v28, v40 row_ror:12 row_mask:0xf bank_mask:2
    v_add_f32_dpp v39, v25, v39 row_ror:8 row_mask:0xf bank_mask:2
    v_add_f32_dpp v38, v18, v38 row_ror:4 row_mask:0xf bank_mask:2
    s_nop 0
    s_nop 0
    v_add_f32_dpp v41, v32, v41 row_ror:12 row_mask:0xf bank_mask:2
    v_add_f32_dpp v40, v29, v40 row_ror:8 row_mask:0xf bank_mask:2
    v_add_f32_dpp v39, v22, v39 row_ror:4 row_mask:0xf bank_mask:2
    s_nop 0
    s_nop 0
    s_nop 0
    v_add_f32_dpp v41, v33, v41 row_ror:8 row_mask:0xf bank_mask:2
    v_add_f32_dpp v40, v26, v40 row_ror:4 row_mask:0xf bank_mask:2
    s_nop 0
    s_nop 0
    s_nop 0
    s_nop 0
    v_add_f32_dpp v41, v30, v41 row_ror:4 row_mask:0xf bank_mask:2
    s_nop 0
    s_nop 0
    s_nop 0
    s_nop 0
    s_nop 0
    v_mov_b32 v50, 0xff7fffff
    s_cmp_gt_u32 s75, 1
    s_cselect_b32 s86, 0, 0xf000f0
    s_cselect_b32 s87, 0, 0xf000f0
    v_cndmask_b32 v39, v39, v50, s[86:87]
    s_cmp_gt_u32 s75, 2
    s_cselect_b32 s86, 0, 0xf000f0
    s_cselect_b32 s87, 0, 0xf000f0
    v_cndmask_b32 v40, v40, v50, s[86:87]
    s_cmp_gt_u32 s75, 3
    s_cselect_b32 s86, 0, 0xf000f0
    s_cselect_b32 s87, 0, 0xf000f0
    v_cndmask_b32 v41, v41, v50, s[86:87]
    s_mov_b32 s86, 1035273459
    s_mov_b32 s87, 1069066811
    s_mov_b32 s88, 0xffff0000
    v_cvt_pk_bf16_f32 v50, v34, v35
    v_lshlrev_b32 v34, 16, v50
    v_and_b32 v35, s88, v50
    v_mul_f32 v34, s86, v34
    v_mul_f32 v35, s86, v35
    v_cvt_pk_bf16_f32 v50, v34, v35
    v_lshlrev_b32 v34, 16, v50
    v_and_b32 v35, s88, v50
    v_cvt_pk_bf16_f32 v51, v36, v37
    v_lshlrev_b32 v36, 16, v51
    v_and_b32 v37, s88, v51
    v_mul_f32 v36, s86, v36
    v_mul_f32 v37, s86, v37
    v_cvt_pk_bf16_f32 v51, v36, v37
    v_lshlrev_b32 v36, 16, v51
    v_and_b32 v37, s88, v51
    v_cvt_pk_bf16_f32 v52, v38, v39
    v_lshlrev_b32 v38, 16, v52
    v_and_b32 v39, s88, v52
    v_mul_f32 v38, s86, v38
    v_mul_f32 v39, s86, v39
    v_cvt_pk_bf16_f32 v52, v38, v39
    v_lshlrev_b32 v38, 16, v52
    v_and_b32 v39, s88, v52
    v_cvt_pk_bf16_f32 v53, v40, v41
    v_lshlrev_b32 v40, 16, v53
    v_and_b32 v41, s88, v53
    v_mul_f32 v40, s86, v40
    v_mul_f32 v41, s86, v41
    v_cvt_pk_bf16_f32 v53, v40, v41
    v_lshlrev_b32 v40, 16, v53
    v_and_b32 v41, s88, v53
    v_max3_f32 v50, v34, v35, v36
    v_max3_f32 v50, v50, v37, v60
    v_max3_f32 v51, v38, v39, v40
    v_max3_f32 v50, v50, v51, v41
    s_nop 1
    v_max_f32_dpp v50, v50, v50 row_ror:4 row_mask:0xf bank_mask:0xf
    s_nop 1
    v_max_f32_dpp v50, v50, v50 row_ror:8 row_mask:0xf bank_mask:0xf
    v_mov_b32 v51, v50
    s_nop 1
    v_permlane16_swap_b32 v50, v51
    v_max_f32 v50, v50, v51
    v_mov_b32 v51, v50
    s_nop 1
    v_permlane32_swap_b32 v50, v51
    v_max_f32 v50, v50, v51
    v_sub_f32 v53, v60, v50
    v_mul_f32 v53, s87, v53
    v_exp_f32 v53, v53
    v_mul_f32 v52, s87, v50
    v_sub_f32 v52, 0, v52
    v_fma_f32 v34, v34, s87, v52
    v_fma_f32 v35, v35, s87, v52
    v_fma_f32 v36, v36, s87, v52
    v_fma_f32 v37, v37, s87, v52
    v_fma_f32 v38, v38, s87, v52
    v_fma_f32 v39, v39, s87, v52
    v_fma_f32 v40, v40, s87, v52
    v_fma_f32 v41, v41, s87, v52
    v_exp_f32 v34, v34
    v_exp_f32 v35, v35
    v_exp_f32 v36, v36
    v_exp_f32 v37, v37
    v_exp_f32 v38, v38
    v_exp_f32 v39, v39
    v_exp_f32 v40, v40
    v_exp_f32 v41, v41
    v_mul_f32 v51, v61, v53
    v_mul_f32 v64, v64, v53
    v_mul_f32 v65, v65, v53
    v_mul_f32 v66, v66, v53
    v_mul_f32 v67, v67, v53
    v_mul_f32 v68, v68, v53
    v_mul_f32 v69, v69, v53
    v_mul_f32 v70, v70, v53
    v_mul_f32 v71, v71, v53
    v_mul_f32 v72, v72, v53
    v_mul_f32 v73, v73, v53
    v_mul_f32 v74, v74, v53
    v_mul_f32 v75, v75, v53
    v_mul_f32 v76, v76, v53
    v_mul_f32 v77, v77, v53
    v_mul_f32 v78, v78, v53
    v_mul_f32 v79, v79, v53
    v_mul_f32 v80, v80, v53
    v_mul_f32 v81, v81, v53
    v_mul_f32 v82, v82, v53
    v_mul_f32 v83, v83, v53
    v_mul_f32 v84, v84, v53
    v_mul_f32 v85, v85, v53
    v_mul_f32 v86, v86, v53
    v_mul_f32 v87, v87, v53
    v_mul_f32 v88, v88, v53
    v_mul_f32 v89, v89, v53
    v_mul_f32 v90, v90, v53
    v_mul_f32 v91, v91, v53
    v_mul_f32 v92, v92, v53
    v_mul_f32 v93, v93, v53
    v_mul_f32 v94, v94, v53
    v_mul_f32 v95, v95, v53
    v_cvt_pk_bf16_f32 v18, v34, v35
    v_cvt_pk_bf16_f32 v19, v36, v37
    v_cvt_pk_bf16_f32 v20, v38, v39
    v_cvt_pk_bf16_f32 v21, v40, v41
    v_add_f32 v51, v51, v34
    v_add_f32 v51, v51, v35
    v_add_f32 v51, v51, v36
    v_add_f32 v51, v51, v37
    v_add_f32 v51, v51, v38
    v_add_f32 v51, v51, v39
    v_add_f32 v51, v51, v40
    v_add_f32 v51, v51, v41
    s_nop 1
    v_add_f32_dpp v51, v51, v51 row_ror:4 row_mask:0xf bank_mask:0xf
    s_nop 1
    v_add_f32_dpp v51, v51, v51 row_ror:8 row_mask:0xf bank_mask:0xf
    v_mov_b32 v53, v51
    s_nop 1
    v_permlane16_swap_b32 v51, v53
    v_add_f32 v51, v51, v53
    v_mov_b32 v53, v51
    s_nop 1
    v_permlane32_swap_b32 v51, v53
    v_add_f32 v51, v51, v53
    s_mov_b32 s69, 4
    s_branch L_stats
L_stats_ret_4:
    ds_read_b64_tr_b16 v[96:97], v6 offset:0
    ds_read_b64_tr_b16 v[100:101], v7 offset:0
    ds_read_b64_tr_b16 v[104:105], v8 offset:0
    ds_read_b64_tr_b16 v[108:109], v9 offset:0
    ds_read_b64_tr_b16 v[112:113], v10 offset:0
    ds_read_b64_tr_b16 v[116:117], v11 offset:0
    ds_read_b64_tr_b16 v[120:121], v12 offset:0
    ds_read_b64_tr_b16 v[124:125], v13 offset:0
    ds_read_b64_tr_b16 v[98:99], v6 offset:4096
    ds_read_b64_tr_b16 v[102:103], v7 offset:4096
    ds_read_b64_tr_b16 v[106:107], v8 offset:4096
    ds_read_b64_tr_b16 v[110:111], v9 offset:4096
    ds_read_b64_tr_b16 v[114:115], v10 offset:4096
    ds_read_b64_tr_b16 v[118:119], v11 offset:4096
    ds_read_b64_tr_b16 v[122:123], v12 offset:4096
    ds_read_b64_tr_b16 v[126:127], v13 offset:4096
    s_waitcnt lgkmcnt(7)
    v_mfma_f32_16x16x32_bf16 v[64:67], v[96:99], v[18:21], v[64:67]
    s_waitcnt lgkmcnt(6)
    v_mfma_f32_16x16x32_bf16 v[68:71], v[100:103], v[18:21], v[68:71]
    s_waitcnt lgkmcnt(5)
    v_mfma_f32_16x16x32_bf16 v[72:75], v[104:107], v[18:21], v[72:75]
    s_waitcnt lgkmcnt(4)
    v_mfma_f32_16x16x32_bf16 v[76:79], v[108:111], v[18:21], v[76:79]
    s_waitcnt lgkmcnt(3)
    v_mfma_f32_16x16x32_bf16 v[80:83], v[112:115], v[18:21], v[80:83]
    s_waitcnt lgkmcnt(2)
    v_mfma_f32_16x16x32_bf16 v[84:87], v[116:119], v[18:21], v[84:87]
    s_waitcnt lgkmcnt(1)
    v_mfma_f32_16x16x32_bf16 v[88:91], v[120:123], v[18:21], v[88:91]
    s_waitcnt lgkmcnt(0)
    v_mfma_f32_16x16x32_bf16 v[92:95], v[124:127], v[18:21], v[92:95]
    v_mov_b32_dpp v30, v18 row_ror:12 row_mask:0xf bank_mask:0xf
    v_mov_b32_dpp v31, v19 row_ror:12 row_mask:0xf bank_mask:0xf
    v_mov_b32_dpp v32, v20 row_ror:12 row_mask:0xf bank_mask:0xf
    v_mov_b32_dpp v33, v21 row_ror:12 row_mask:0xf bank_mask:0xf
    s_waitcnt vmcnt(4)
    ds_read_b64_tr_b16 v[128:129], v6 offset:8192
    ds_read_b64_tr_b16 v[132:133], v7 offset:8192
    ds_read_b64_tr_b16 v[136:137], v8 offset:8192
    ds_read_b64_tr_b16 v[140:141], v9 offset:8192
    ds_read_b64_tr_b16 v[144:145], v10 offset:8192
    ds_read_b64_tr_b16 v[148:149], v11 offset:8192
    ds_read_b64_tr_b16 v[152:153], v12 offset:8192
    ds_read_b64_tr_b16 v[156:157], v13 offset:8192
    s_waitcnt vmcnt(0)
    ds_read_b64_tr_b16 v[130:131], v6 offset:12288
    ds_read_b64_tr_b16 v[134:135], v7 offset:12288
    ds_read_b64_tr_b16 v[138:139], v8 offset:12288
    ds_read_b64_tr_b16 v[142:143], v9 offset:12288
    ds_read_b64_tr_b16 v[146:147], v10 offset:12288
    ds_read_b64_tr_b16 v[150:151], v11 offset:12288
    ds_read_b64_tr_b16 v[154:155], v12 offset:12288
    ds_read_b64_tr_b16 v[158:159], v13 offset:12288
    s_waitcnt lgkmcnt(7)
    v_mfma_f32_16x16x32_bf16 v[64:67], v[128:131], v[30:33], v[64:67]
    s_waitcnt lgkmcnt(6)
    v_mfma_f32_16x16x32_bf16 v[68:71], v[132:135], v[30:33], v[68:71]
    s_waitcnt lgkmcnt(5)
    v_mfma_f32_16x16x32_bf16 v[72:75], v[136:139], v[30:33], v[72:75]
    s_waitcnt lgkmcnt(4)
    v_mfma_f32_16x16x32_bf16 v[76:79], v[140:143], v[30:33], v[76:79]
    s_waitcnt lgkmcnt(3)
    v_mfma_f32_16x16x32_bf16 v[80:83], v[144:147], v[30:33], v[80:83]
    s_waitcnt lgkmcnt(2)
    v_mfma_f32_16x16x32_bf16 v[84:87], v[148:151], v[30:33], v[84:87]
    s_waitcnt lgkmcnt(1)
    v_mfma_f32_16x16x32_bf16 v[88:91], v[152:155], v[30:33], v[88:91]
    s_waitcnt lgkmcnt(0)
    v_mfma_f32_16x16x32_bf16 v[92:95], v[156:159], v[30:33], v[92:95]
    s_branch L_vdone
L_r2_5:
    s_nop 1
    s_waitcnt vmcnt(3)
    s_add_u32 s83, s77, 0
    buffer_load_dwordx4 v[192:195], v1, s[4:7], s83 offen offset:0 nt
    s_waitcnt vmcnt(3)
    buffer_load_dwordx4 v[196:199], v1, s[4:7], s83 offen offset:1024 nt
    s_waitcnt vmcnt(17)
    v_mfma_f32_16x16x32_bf16 v[18:21], v[160:163], v[14:17], 0
    s_nop 0
    s_nop 0
    s_nop 0
    s_nop 0
    s_waitcnt vmcnt(3)
    buffer_load_dwordx4 v[200:203], v1, s[4:7], s83 offen offset:2048 nt
    s_waitcnt vmcnt(3)
    buffer_load_dwordx4 v[204:207], v1, s[4:7], s83 offen offset:3072 nt
    s_waitcnt vmcnt(18)
    v_mfma_f32_16x16x32_bf16 v[22:25], v[164:167], v[14:17], 0
    s_nop 0
    s_nop 0
    s_nop 0
    s_nop 0
    s_waitcnt vmcnt(3)
    s_add_u32 s83, s77, 32768
    buffer_load_dwordx4 v[208:211], v1, s[4:7], s83 offen offset:0 nt
    s_waitcnt vmcnt(3)
    buffer_load_dwordx4 v[212:215], v1, s[4:7], s83 offen offset:1024 nt
    s_waitcnt vmcnt(19)
    v_mfma_f32_16x16x32_bf16 v[26:29], v[168:171], v[14:17], 0
    v_mov_b32_dpp v34, v18 quad_perm:[0,1,2,3] row_mask:0xf bank_mask:1
    s_nop 0
    s_nop 0
    s_nop 0
    s_waitcnt vmcnt(3)
    buffer_load_dwordx4 v[216:219], v1, s[4:7], s83 offen offset:2048 nt
    s_waitcnt vmcnt(3)
    buffer_load_dwordx4 v[220:223], v1, s[4:7], s83 offen offset:3072 nt
    s_waitcnt vmcnt(20)
    v_mfma_f32_16x16x32_bf16 v[30:33], v[172:175], v[14:17], 0
    v_mov_b32_dpp v35, v22 quad_perm:[0,1,2,3] row_mask:0xf bank_mask:1
    v_add_f32_dpp v34, v19, v34 row_ror:12 row_mask:0xf bank_mask:1
    s_nop 0
    s_nop 0
    s_waitcnt vmcnt(3)
    s_mov_b32 s83, s76
    buffer_load_dwordx4 v[224:227], v1, s[4:7], s83 offen offset:0 nt
    s_waitcnt vmcnt(3)
    s_cmp_gt_u32 s75, 1
    s_cselect_b32 s83, s83, s59
    buffer_load_dwordx4 v[228:231], v1, s[4:7], s83 offen offset:1024 nt
    s_waitcnt vmcnt(21)
    v_mfma_f32_16x16x32_bf16 v[50:53], v[176:179], v[14:17], 0
    v_mov_b32_dpp v36, v26 quad_perm:[0,1,2,3] row_mask:0xf bank_mask:1
    v_add_f32_dpp v35, v23, v35 row_ror:12 row_mask:0xf bank_mask:1
    v_add_f32_dpp v34, v20, v34 row_ror:8 row_mask:0xf bank_mask:1
    s_nop 0
    s_waitcnt vmcnt(3)
    s_cmp_gt_u32 s75, 2
    s_cselect_b32 s83, s83, s59
    buffer_load_dwordx4 v[232:235], v1, s[4:7], s83 offen offset:2048 nt
    s_waitcnt vmcnt(3)
    s_cmp_gt_u32 s75, 3
    s_cselect_b32 s83, s83, s59
    buffer_load_dwordx4 v[236:239], v1, s[4:7], s83 offen offset:3072 nt
    s_waitcnt vmcnt(22)
    v_mfma_f32_16x16x32_bf16 v[54:57], v[180:183], v[14:17], 0
    v_mov_b32_dpp v37, v30 quad_perm:[0,1,2,3] row_mask:0xf bank_mask:1
    v_add_f32_dpp v36, v27, v36 row_ror:12 row_mask:0xf bank_mask:1
    v_add_f32_dpp v35, v24, v35 row_ror:8 row_mask:0xf bank_mask:1
    v_add_f32_dpp v34, v21, v34 row_ror:4 row_mask:0xf bank_mask:1
    s_waitcnt vmcnt(3)
    s_add_u32 s84, s77, 0
    s_add_u32 m0, s80, 8192
    s_nop 0
    buffer_load_dwordx4 v2, s[8:11], s84 offen offset:0 nt lds
    s_waitcnt vmcnt(3)
    buffer_load_dwordx4 v3, s[8:11], s84 offen offset:1024 nt lds
    s_waitcnt vmcnt(23)
    v_mfma_f32_16x16x32_bf16 v[18:21], v[184:187], v[14:17], 0
    v_mov_b32_dpp v38, v50 quad_perm:[0,1,2,3] row_mask:0xf bank_mask:1
    v_add_f32_dpp v37, v31, v37 row_ror:12 row_mask:0xf bank_mask:1
    v_add_f32_dpp v36, v28, v36 row_ror:8 row_mask:0xf bank_mask:1
    v_add_f32_dpp v35, v25, v35 row_ror:4 row_mask:0xf bank_mask:1
    s_waitcnt vmcnt(3)
    buffer_load_dwordx4 v4, s[8:11], s84 offen offset:2048 nt lds
    s_waitcnt vmcnt(3)
    buffer_load_dwordx4 v5, s[8:11], s84 offen offset:3072 nt lds
    s_waitcnt vmcnt(24)
    v_mfma_f32_16x16x32_bf16 v[22:25], v[188:191], v[14:17], 0
    v_mov_b32_dpp v39, v54 quad_perm:[0,1,2,3] row_mask:0xf bank_mask:1
    v_add_f32_dpp v38, v51, v38 row_ror:12 row_mask:0xf bank_mask:1
    v_add_f32_dpp v37, v32, v37 row_ror:8 row_mask:0xf bank_mask:1
    v_add_f32_dpp v36, v29, v36 row_ror:4 row_mask:0xf bank_mask:1
    s_waitcnt vmcnt(3)
    s_add_u32 s84, s77, 32768
    s_add_u32 m0, s80, 12288
    s_nop 0
    buffer_load_dwordx4 v2, s[8:11], s84 offen offset:0 nt lds
    s_waitcnt vmcnt(16)
    v_mfma_f32_16x16x32_bf16 v[26:29], v[192:195], v[14:17], 0
    v_mov_b32_dpp v40, v18 quad_perm:[0,1,2,3] row_mask:0xf bank_mask:1
    v_add_f32_dpp v39, v55, v39 row_ror:12 row_mask:0xf bank_mask:1
    v_add_f32_dpp v38, v52, v38 row_ror:8 row_mask:0xf bank_mask:1
    v_add_f32_dpp v37, v33, v37 row_ror:4 row_mask:0xf bank_mask:1
    s_waitcnt vmcnt(3)
    buffer_load_dwordx4 v3, s[8:11], s84 offen offset:1024 nt lds
    s_waitcnt vmcnt(16)
    v_mfma_f32_16x16x32_bf16 v[30:33], v[196:199], v[14:17], 0
    v_mov_b32_dpp v41, v22 quad_perm:[0,1,2,3] row_mask:0xf bank_mask:1
    v_add_f32_dpp v40, v19, v40 row_ror:12 row_mask:0xf bank_mask:1
    v_add_f32_dpp v39, v56, v39 row_ror:8 row_mask:0xf bank_mask:1
    v_add_f32_dpp v38, v53, v38 row_ror:4 row_mask:0xf bank_mask:1
    s_waitcnt vmcnt(3)
    buffer_load_dwordx4 v4, s[8:11], s84 offen offset:2048 nt lds
    s_waitcnt vmcnt(16)
    v_mfma_f32_16x16x32_bf16 v[50:53], v[200:203], v[14:17], 0
    v_mov_b32_dpp v34, v27 quad_perm:[0,1,2,3] row_mask:0xf bank_mask:2
    v_add_f32_dpp v41, v23, v41 row_ror:12 row_mask:0xf bank_mask:1
    v_add_f32_dpp v40, v20, v40 row_ror:8 row_mask:0xf bank_mask:1
    v_add_f32_dpp v39, v57, v39 row_ror:4 row_mask:0xf bank_mask:1
    s_waitcnt vmcnt(3)
    buffer_load_dwordx4 v5, s[8:11], s84 offen offset:3072 nt lds
    s_waitcnt vmcnt(16)
    v_mfma_f32_16x16x32_bf16 v[54:57], v[204:207], v[14:17], 0
    v_mov_b32_dpp v35, v31 quad_perm:[0,1,2,3] row_mask:0xf bank_mask:2
    v_add_f32_dpp v34, v28, v34 row_ror:12 row_mask:0xf bank_mask:2
    v_add_f32_dpp v41, v24, v41 row_ror:8 row_mask:0xf bank_mask:1
    v_add_f32_dpp v40, v21, v40 row_ror:4 row_mask:0xf bank_mask:1
    s_waitcnt vmcnt(15)
    v_mfma_f32_16x16x32_bf16 v[18:21], v[208:211], v[14:17], 0
    v_mov_b32_dpp v36, v51 quad_perm:[0,1,2,3] row_mask:0xf bank_mask:2
    v_add_f32_dpp v35, v32, v35 row_ror:12 row_mask:0xf bank_mask:2
    v_add_f32_dpp v34, v29, v34 row_ror:8 row_mask:0xf bank_mask:2
    v_add_f32_dpp v41, v25, v41 row_ror:4 row_mask:0xf bank_mask:1
    s_waitcnt vmcnt(14)
    v_mfma_f32_16x16x32_bf16 v[22:25], v[212:215], v[14:17], 0
    v_mov_b32_dpp v37, v55 quad_perm:[0,1,2,3] row_mask:0xf bank_mask:2
    v_add_f32_dpp v36, v52, v36 row_ror:12 row_mask:0xf bank_mask:2
    v_add_f32_dpp v35, v33, v35 row_ror:8 row_mask:0xf bank_mask:2
    v_add_f32_dpp v34, v26, v34 row_ror:4 row_mask:0xf bank_mask:2
    s_waitcnt vmcnt(13)
    v_mfma_f32_16x16x32_bf16 v[26:29], v[216:219], v[14:17], 0
    v_mov_b32_dpp v38, v19 quad_perm:[0,1,2,3] row_mask:0xf bank_mask:2
    v_add_f32_dpp v37, v56, v37 row_ror:12 row_mask:0xf bank_mask:2
    v_add_f32_dpp v36, v53, v36 row_ror:8 row_mask:0xf bank_mask:2
    v_add_f32_dpp v35, v30, v35 row_ror:4 row_mask:0xf bank_mask:2
    s_waitcnt vmcnt(12)
    v_mfma_f32_16x16x32_bf16 v[30:33], v[220:223], v[14:17], 0
    v_mov_b32_dpp v39, v23 quad_perm:[0,1,2,3] row_mask:0xf bank_mask:2
    v_add_f32_dpp v38, v20, v38 row_ror:12 row_mask:0xf bank_mask:2
    v_add_f32_dpp v37, v57, v37 row_ror:8 row_mask:0xf bank_mask:2
    v_add_f32_dpp v36, v50, v36 row_ror:4 row_mask:0xf bank_mask:2
    s_waitcnt vmcnt(11)
    v_mfma_f32_16x16x32_bf16 v[50:53], v[224:227], v[14:17], 0
    v_mov_b32_dpp v40, v27 quad_perm:[0,1,2,3] row_mask:0xf bank_mask:2
    v_add_f32_dpp v39, v24, v39 row_ror:12 row_mask:0xf bank_mask:2
    v_add_f32_dpp v38, v21, v38 row_ror:8 row_mask:0xf bank_mask:2
    v_add_f32_dpp v37, v54, v37 row_ror:4 row_mask:0xf bank_mask:2
    s_waitcnt vmcnt(10)
    v_mfma_f32_16x16x32_bf16 v[54:57], v[228:231], v[14:17], 0
    v_mov_b32_dpp v41, v31 quad_perm:[0,1,2,3] row_mask:0xf bank_mask:2
    v_add_f32_dpp v40, v28, v40 row_ror:12 row_mask:0xf bank_mask:2
    v_add_f32_dpp v39, v25, v39 row_ror:8 row_mask:0xf bank_mask:2
    v_add_f32_dpp v38, v18, v38 row_ror:4 row_mask:0xf bank_mask:2
    s_waitcnt vmcnt(9)
    v_mfma_f32_16x16x32_bf16 v[18:21], v[232:235], v[14:17], 0
    v_mov_b32_dpp v34, v52 quad_perm:[0,1,2,3] row_mask:0xf bank_mask:4
    v_add_f32_dpp v41, v32, v41 row_ror:12 row_mask:0xf bank_mask:2
    v_add_f32_dpp v40, v29, v40 row_ror:8 row_mask:0xf bank_mask:2
    v_add_f32_dpp v39, v22, v39 row_ror:4 row_mask:0xf bank_mask:2
    s_waitcnt vmcnt(8)
    v_mfma_f32_16x16x32_bf16 v[22:25], v[236:239], v[14:17], 0
    v_mov_b32_dpp v35, v56 quad_perm:[0,1,2,3] row_mask:0xf bank_mask:4
    v_add_f32_dpp v34, v53, v34 row_ror:12 row_mask:0xf bank_mask:4
    v_add_f32_dpp v41, v33, v41 row_ror:8 row_mask:0xf bank_mask:2
    v_add_f32_dpp v40, v26, v40 row_ror:4 row_mask:0xf bank_mask:2
    s_nop 0
    v_mov_b32_dpp v36, v20 quad_perm:[0,1,2,3] row_mask:0xf bank_mask:4
    v_add_f32_dpp v35, v57, v35 row_ror:12 row_mask:0xf bank_mask:4
    v_add_f32_dpp v34, v50, v34 row_ror:8 row_mask:0xf bank_mask:4
    v_add_f32_dpp v41, v30, v41 row_ror:4 row_mask:0xf bank_mask:2
    s_nop 0
    v_mov_b32_dpp v37, v24 quad_perm:[0,1,2,3] row_mask:0xf bank_mask:4
    v_add_f32_dpp v36, v21, v36 row_ror:12 row_mask:0xf bank_mask:4
    v_add_f32_dpp v35, v54, v35 row_ror:8 row_mask:0xf bank_mask:4
    v_add_f32_dpp v34, v51, v34 row_ror:4 row_mask:0xf bank_mask:4
    s_nop 0
    s_nop 0
    v_add_f32_dpp v37, v25, v37 row_ror:12 row_mask:0xf bank_mask:4
    v_add_f32_dpp v36, v18, v36 row_ror:8 row_mask:0xf bank_mask:4
    v_add_f32_dpp v35, v55, v35 row_ror:4 row_mask:0xf bank_mask:4
    s_nop 0
    s_nop 0
    s_nop 0
    v_add_f32_dpp v37, v22, v37 row_ror:8 row_mask:0xf bank_mask:4
    v_add_f32_dpp v36, v19, v36 row_ror:4 row_mask:0xf bank_mask:4
    s_nop 0
    s_nop 0
    s_nop 0
    s_nop 0
    v_add_f32_dpp v37, v23, v37 row_ror:4 row_mask:0xf bank_mask:4
    s_nop 0
    s_nop 0
    s_nop 0
    s_nop 0
    s_nop 0
    v_mov_b32 v50, 0xff7fffff
    s_cmp_gt_u32 s75, 1
    s_cselect_b32 s86, 0, 0xf000f00
    s_cselect_b32 s87, 0, 0xf000f00
    v_cndmask_b32 v35, v35, v50, s[86:87]
    s_cmp_gt_u32 s75, 2
    s_cselect_b32 s86, 0, 0xf000f00
    s_cselect_b32 s87, 0, 0xf000f00
    v_cndmask_b32 v36, v36, v50, s[86:87]
    s_cmp_gt_u32 s75, 3
    s_cselect_b32 s86, 0, 0xf000f00
    s_cselect_b32 s87, 0, 0xf000f00
    v_cndmask_b32 v37, v37, v50, s[86:87]
    s_mov_b32 s86, 1035273459
    s_mov_b32 s87, 1069066811
    s_mov_b32 s88, 0xffff0000
    v_cvt_pk_bf16_f32 v50, v34, v35
    v_lshlrev_b32 v34, 16, v50
    v_and_b32 v35, s88, v50
    v_mul_f32 v34, s86, v34
    v_mul_f32 v35, s86, v35
    v_cvt_pk_bf16_f32 v50, v34, v35
    v_lshlrev_b32 v34, 16, v50
    v_and_b32 v35, s88, v50
    v_cvt_pk_bf16_f32 v51, v36, v37
    v_lshlrev_b32 v36, 16, v51
    v_and_b32 v37, s88, v51
    v_mul_f32 v36, s86, v36
    v_mul_f32 v37, s86, v37
    v_cvt_pk_bf16_f32 v51, v36, v37
    v_lshlrev_b32 v36, 16, v51
    v_and_b32 v37, s88, v51
    v_cvt_pk_bf16_f32 v52, v38, v39
    v_lshlrev_b32 v38, 16, v52
    v_and_b32 v39, s88, v52
    v_mul_f32 v38, s86, v38
    v_mul_f32 v39, s86, v39
    v_cvt_pk_bf16_f32 v52, v38, v39
    v_lshlrev_b32 v38, 16, v52
    v_and_b32 v39, s88, v52
    v_cvt_pk_bf16_f32 v53, v40, v41
    v_lshlrev_b32 v40, 16, v53
    v_and_b32 v41, s88, v53
    v_mul_f32 v40, s86, v40
    v_mul_f32 v41, s86, v41
    v_cvt_pk_bf16_f32 v53, v40, v41
    v_lshlrev_b32 v40, 16, v53
    v_and_b32 v41, s88, v53
    v_max3_f32 v50, v34, v35, v36
    v_max3_f32 v50, v50, v37, v60
    v_max3_f32 v51, v38, v39, v40
    v_max3_f32 v50, v50, v51, v41
    s_nop 1
    v_max_f32_dpp v50, v50, v50 row_ror:4 row_mask:0xf bank_mask:0xf
    s_nop 1
    v_max_f32_dpp v50, v50, v50 row_ror:8 row_mask:0xf bank_mask:0xf
    v_mov_b32 v51, v50
    s_nop 1
    v_permlane16_swap_b32 v50, v51
    v_max_f32 v50, v50, v51
    v_mov_b32 v51, v50
    s_nop 1
    v_permlane32_swap_b32 v50, v51
    v_max_f32 v50, v50, v51
    v_sub_f32 v53, v60, v50
    v_mul_f32 v53, s87, v53
    v_exp_f32 v53, v53
    v_mul_f32 v52, s87, v50
    v_sub_f32 v52, 0, v52
    v_fma_f32 v34, v34, s87, v52
    v_fma_f32 v35, v35, s87, v52
    v_fma_f32 v36, v36, s87, v52
    v_fma_f32 v37, v37, s87, v52
    v_fma_f32 v38, v38, s87, v52
    v_fma_f32 v39, v39, s87, v52
    v_fma_f32 v40, v40, s87, v52
    v_fma_f32 v41, v41, s87, v52
    v_exp_f32 v34, v34
    v_exp_f32 v35, v35
    v_exp_f32 v36, v36
    v_exp_f32 v37, v37
    v_exp_f32 v38, v38
    v_exp_f32 v39, v39
    v_exp_f32 v40, v40
    v_exp_f32 v41, v41
    v_mul_f32 v51, v61, v53
    v_mul_f32 v64, v64, v53
    v_mul_f32 v65, v65, v53
    v_mul_f32 v66, v66, v53
    v_mul_f32 v67, v67, v53
    v_mul_f32 v68, v68, v53
    v_mul_f32 v69, v69, v53
    v_mul_f32 v70, v70, v53
    v_mul_f32 v71, v71, v53
    v_mul_f32 v72, v72, v53
    v_mul_f32 v73, v73, v53
    v_mul_f32 v74, v74, v53
    v_mul_f32 v75, v75, v53
    v_mul_f32 v76, v76, v53
    v_mul_f32 v77, v77, v53
    v_mul_f32 v78, v78, v53
    v_mul_f32 v79, v79, v53
    v_mul_f32 v80, v80, v53
    v_mul_f32 v81, v81, v53
    v_mul_f32 v82, v82, v53
    v_mul_f32 v83, v83, v53
    v_mul_f32 v84, v84, v53
    v_mul_f32 v85, v85, v53
    v_mul_f32 v86, v86, v53
    v_mul_f32 v87, v87, v53
    v_mul_f32 v88, v88, v53
    v_mul_f32 v89, v89, v53
    v_mul_f32 v90, v90, v53
    v_mul_f32 v91, v91, v53
    v_mul_f32 v92, v92, v53
    v_mul_f32 v93, v93, v53
    v_mul_f32 v94, v94, v53
    v_mul_f32 v95, v95, v53
    v_cvt_pk_bf16_f32 v18, v34, v35
    v_cvt_pk_bf16_f32 v19, v36, v37
    v_cvt_pk_bf16_f32 v20, v38, v39
    v_cvt_pk_bf16_f32 v21, v40, v41
    v_add_f32 v51, v51, v34
    v_add_f32 v51, v51, v35
    v_add_f32 v51, v51, v36
    v_add_f32 v51, v51, v37
    v_add_f32 v51, v51, v38
    v_add_f32 v51, v51, v39
    v_add_f32 v51, v51, v40
    v_add_f32 v51, v51, v41
    s_nop 1
    v_add_f32_dpp v51, v51, v51 row_ror:4 row_mask:0xf bank_mask:0xf
    s_nop 1
    v_add_f32_dpp v51, v51, v51 row_ror:8 row_mask:0xf bank_mask:0xf
    v_mov_b32 v53, v51
    s_nop 1
    v_permlane16_swap_b32 v51, v53
    v_add_f32 v51, v51, v53
    v_mov_b32 v53, v51
    s_nop 1
    v_permlane32_swap_b32 v51, v53
    v_add_f32 v51, v51, v53
    s_mov_b32 s69, 5
    s_branch L_stats
L_stats_ret_5:
    ds_read_b64_tr_b16 v[96:97], v6 offset:0
    ds_read_b64_tr_b16 v[100:101], v7 offset:0
    ds_read_b64_tr_b16 v[104:105], v8 offset:0
    ds_read_b64_tr_b16 v[108:109], v9 offset:0
    ds_read_b64_tr_b16 v[112:113], v10 offset:0
    ds_read_b64_tr_b16 v[116:117], v11 offset:0
    ds_read_b64_tr_b16 v[120:121], v12 offset:0
    ds_read_b64_tr_b16 v[124:125], v13 offset:0
    s_waitcnt lgkmcnt(0)
    s_waitcnt vmcnt(7)
    s_mov_b32 s84, s76
    s_add_u32 m0, s80, 0
    s_nop 0
    buffer_load_dwordx4 v2, s[8:11], s84 offen offset:0 nt lds
    s_waitcnt vmcnt(7)
    s_cmp_gt_u32 s75, 1
    s_cselect_b32 s84, s84, s59
    buffer_load_dwordx4 v3, s[8:11], s84 offen offset:1024 nt lds
    s_waitcnt vmcnt(7)
    s_cmp_gt_u32 s75, 2
    s_cselect_b32 s84, s84, s59
    buffer_load_dwordx4 v4, s[8:11], s84 offen offset:2048 nt lds
    s_waitcnt vmcnt(7)
    s_cmp_gt_u32 s75, 3
    s_cselect_b32 s84, s84, s59
    buffer_load_dwordx4 v5, s[8:11], s84 offen offset:3072 nt lds
    ds_read_b64_tr_b16 v[98:99], v6 offset:4096
    ds_read_b64_tr_b16 v[102:103], v7 offset:4096
    ds_read_b64_tr_b16 v[106:107], v8 offset:4096
    ds_read_b64_tr_b16 v[110:111], v9 offset:4096
    ds_read_b64_tr_b16 v[114:115], v10 offset:4096
    ds_read_b64_tr_b16 v[118:119], v11 offset:4096
    ds_read_b64_tr_b16 v[122:123], v12 offset:4096
    ds_read_b64_tr_b16 v[126:127], v13 offset:4096
    s_waitcnt lgkmcnt(7)
    v_mfma_f32_16x16x32_bf16 v[64:67], v[96:99], v[18:21], v[64:67]
    s_waitcnt lgkmcnt(6)
    v_mfma_f32_16x16x32_bf16 v[68:71], v[100:103], v[18:21], v[68:71]
    s_waitcnt lgkmcnt(5)
    v_mfma_f32_16x16x32_bf16 v[72:75], v[104:107], v[18:21], v[72:75]
    s_waitcnt lgkmcnt(4)
    v_mfma_f32_16x16x32_bf16 v[76:79], v[108:111], v[18:21], v[76:79]
    s_waitcnt lgkmcnt(3)
    v_mfma_f32_16x16x32_bf16 v[80:83], v[112:115], v[18:21], v[80:83]
    s_waitcnt lgkmcnt(2)
    v_mfma_f32_16x16x32_bf16 v[84:87], v[116:119], v[18:21], v[84:87]
    s_waitcnt lgkmcnt(1)
    v_mfma_f32_16x16x32_bf16 v[88:91], v[120:123], v[18:21], v[88:91]
    s_waitcnt lgkmcnt(0)
    v_mfma_f32_16x16x32_bf16 v[92:95], v[124:127], v[18:21], v[92:95]
    v_mov_b32_dpp v30, v18 row_ror:12 row_mask:0xf bank_mask:0xf
    v_mov_b32_dpp v31, v19 row_ror:12 row_mask:0xf bank_mask:0xf
    v_mov_b32_dpp v32, v20 row_ror:12 row_mask:0xf bank_mask:0xf
    v_mov_b32_dpp v33, v21 row_ror:12 row_mask:0xf bank_mask:0xf
    s_waitcnt vmcnt(8)
    ds_read_b64_tr_b16 v[128:129], v6 offset:8192
    ds_read_b64_tr_b16 v[132:133], v7 offset:8192
    ds_read_b64_tr_b16 v[136:137], v8 offset:8192
    ds_read_b64_tr_b16 v[140:141], v9 offset:8192
    ds_read_b64_tr_b16 v[144:145], v10 offset:8192
    ds_read_b64_tr_b16 v[148:149], v11 offset:8192
    ds_read_b64_tr_b16 v[152:153], v12 offset:8192
    ds_read_b64_tr_b16 v[156:157], v13 offset:8192
    s_waitcnt vmcnt(4)
    ds_read_b64_tr_b16 v[130:131], v6 offset:12288
    ds_read_b64_tr_b16 v[134:135], v7 offset:12288
    ds_read_b64_tr_b16 v[138:139], v8 offset:12288
    ds_read_b64_tr_b16 v[142:143], v9 offset:12288
    ds_read_b64_tr_b16 v[146:147], v10 offset:12288
    ds_read_b64_tr_b16 v[150:151], v11 offset:12288
    ds_read_b64_tr_b16 v[154:155], v12 offset:12288
    ds_read_b64_tr_b16 v[158:159], v13 offset:12288
    s_waitcnt lgkmcnt(7)
    v_mfma_f32_16x16x32_bf16 v[64:67], v[128:131], v[30:33], v[64:67]
    s_waitcnt lgkmcnt(6)
    v_mfma_f32_16x16x32_bf16 v[68:71], v[132:135], v[30:33], v[68:71]
    s_waitcnt lgkmcnt(5)
    v_mfma_f32_16x16x32_bf16 v[72:75], v[136:139], v[30:33], v[72:75]
    s_waitcnt lgkmcnt(4)
    v_mfma_f32_16x16x32_bf16 v[76:79], v[140:143], v[30:33], v[76:79]
    s_waitcnt lgkmcnt(3)
    v_mfma_f32_16x16x32_bf16 v[80:83], v[144:147], v[30:33], v[80:83]
    s_waitcnt lgkmcnt(2)
    v_mfma_f32_16x16x32_bf16 v[84:87], v[148:151], v[30:33], v[84:87]
    s_waitcnt lgkmcnt(1)
    v_mfma_f32_16x16x32_bf16 v[88:91], v[152:155], v[30:33], v[88:91]
    s_waitcnt lgkmcnt(0)
    v_mfma_f32_16x16x32_bf16 v[92:95], v[156:159], v[30:33], v[92:95]
    v_mov_b32_dpp v26, v18 row_ror:8 row_mask:0xf bank_mask:0xf
    v_mov_b32_dpp v27, v19 row_ror:8 row_mask:0xf bank_mask:0xf
    v_mov_b32_dpp v28, v20 row_ror:8 row_mask:0xf bank_mask:0xf
    v_mov_b32_dpp v29, v21 row_ror:8 row_mask:0xf bank_mask:0xf
    s_waitcnt vmcnt(0)
    ds_read_b64_tr_b16 v[96:97], v6 offset:0
    ds_read_b64_tr_b16 v[100:101], v7 offset:0
    ds_read_b64_tr_b16 v[104:105], v8 offset:0
    ds_read_b64_tr_b16 v[108:109], v9 offset:0
    ds_read_b64_tr_b16 v[112:113], v10 offset:0
    ds_read_b64_tr_b16 v[116:117], v11 offset:0
    ds_read_b64_tr_b16 v[120:121], v12 offset:0
    ds_read_b64_tr_b16 v[124:125], v13 offset:0
    s_waitcnt lgkmcnt(7)
    v_mfma_f32_16x16x16_bf16 v[64:67], v[96:97], v[26:27], v[64:67]
    s_waitcnt lgkmcnt(6)
    v_mfma_f32_16x16x16_bf16 v[68:71], v[100:101], v[26:27], v[68:71]
    s_waitcnt lgkmcnt(5)
    v_mfma_f32_16x16x16_bf16 v[72:75], v[104:105], v[26:27], v[72:75]
    s_waitcnt lgkmcnt(4)
    v_mfma_f32_16x16x16_bf16 v[76:79], v[108:109], v[26:27], v[76:79]
    s_waitcnt lgkmcnt(3)
    v_mfma_f32_16x16x16_bf16 v[80:83], v[112:113], v[26:27], v[80:83]
    s_waitcnt lgkmcnt(2)
    v_mfma_f32_16x16x16_bf16 v[84:87], v[116:117], v[26:27], v[84:87]
    s_waitcnt lgkmcnt(1)
    v_mfma_f32_16x16x16_bf16 v[88:91], v[120:121], v[26:27], v[88:91]
    s_waitcnt lgkmcnt(0)
    v_mfma_f32_16x16x16_bf16 v[92:95], v[124:125], v[26:27], v[92:95]
    s_branch L_vdone
L_r2_6:
    s_nop 1
    s_waitcnt vmcnt(3)
    s_add_u32 s83, s77, 0
    buffer_load_dwordx4 v[192:195], v1, s[4:7], s83 offen offset:0 nt
    s_waitcnt vmcnt(3)
    buffer_load_dwordx4 v[196:199], v1, s[4:7], s83 offen offset:1024 nt
    s_waitcnt vmcnt(17)
    v_mfma_f32_16x16x32_bf16 v[18:21], v[160:163], v[14:17], 0
    s_nop 0
    s_nop 0
    s_nop 0
    s_nop 0
    s_waitcnt vmcnt(3)
    buffer_load_dwordx4 v[200:203], v1, s[4:7], s83 offen offset:2048 nt
    s_waitcnt vmcnt(3)
    buffer_load_dwordx4 v[204:207], v1, s[4:7], s83 offen offset:3072 nt
    s_waitcnt vmcnt(18)
    v_mfma_f32_16x16x32_bf16 v[22:25], v[164:167], v[14:17], 0
    s_nop 0
    s_nop 0
    s_nop 0
    s_nop 0
    s_waitcnt vmcnt(3)
    s_add_u32 s83, s77, 32768
    buffer_load_dwordx4 v[208:211], v1, s[4:7], s83 offen offset:0 nt
    s_waitcnt vmcnt(3)
    buffer_load_dwordx4 v[212:215], v1, s[4:7], s83 offen offset:1024 nt
    s_waitcnt vmcnt(19)
    v_mfma_f32_16x16x32_bf16 v[26:29], v[168:171], v[14:17], 0
    v_mov_b32_dpp v34, v18 quad_perm:[0,1,2,3] row_mask:0xf bank_mask:1
    s_nop 0
    s_nop 0
    s_nop 0
    s_waitcnt vmcnt(3)
    buffer_load_dwordx4 v[216:219], v1, s[4:7], s83 offen offset:2048 nt
    s_waitcnt vmcnt(3)
    buffer_load_dwordx4 v[220:223], v1, s[4:7], s83 offen offset:3072 nt
    s_waitcnt vmcnt(20)
    v_mfma_f32_16x16x32_bf16 v[30:33], v[172:175], v[14:17], 0
    v_mov_b32_dpp v35, v22 quad_perm:[0,1,2,3] row_mask:0xf bank_mask:1
    v_add_f32_dpp v34, v19, v34 row_ror:12 row_mask:0xf bank_mask:1
    s_nop 0
    s_nop 0
    s_waitcnt vmcnt(3)
    s_add_u32 s83, s77, 65536
    buffer_load_dwordx4 v[224:227], v1, s[4:7], s83 offen offset:0 nt
    s_waitcnt vmcnt(3)
    buffer_load_dwordx4 v[228:231], v1, s[4:7], s83 offen offset:1024 nt
    s_waitcnt vmcnt(21)
    v_mfma_f32_16x16x32_bf16 v[50:53], v[176:179], v[14:17], 0
    v_mov_b32_dpp v36, v26 quad_perm:[0,1,2,3] row_mask:0xf bank_mask:1
    v_add_f32_dpp v35, v23, v35 row_ror:12 row_mask:0xf bank_mask:1
    v_add_f32_dpp v34, v20, v34 row_ror:8 row_mask:0xf bank_mask:1
    s_nop 0
    s_waitcnt vmcnt(3)
    buffer_load_dwordx4 v[232:235], v1, s[4:7], s83 offen offset:2048 nt
    s_waitcnt vmcnt(3)
    buffer_load_dwordx4 v[236:239], v1, s[4:7], s83 offen offset:3072 nt
    s_waitcnt vmcnt(22)
    v_mfma_f32_16x16x32_bf16 v[54:57], v[180:183], v[14:17], 0
    v_mov_b32_dpp v37, v30 quad_perm:[0,1,2,3] row_mask:0xf bank_mask:1
    v_add_f32_dpp v36, v27, v36 row_ror:12 row_mask:0xf bank_mask:1
    v_add_f32_dpp v35, v24, v35 row_ror:8 row_mask:0xf bank_mask:1
    v_add_f32_dpp v34, v21, v34 row_ror:4 row_mask:0xf bank_mask:1
    s_waitcnt vmcnt(3)
    s_mov_b32 s83, s76
    buffer_load_dwordx4 v[240:243], v1, s[4:7], s83 offen offset:0 nt
    s_waitcnt vmcnt(3)
    s_cmp_gt_u32 s75, 1
    s_cselect_b32 s83, s83, s59
    buffer_load_dwordx4 v[244:247], v1, s[4:7], s83 offen offset:1024 nt
    s_waitcnt vmcnt(23)
    v_mfma_f32_16x16x32_bf16 v[18:21], v[184:187], v[14:17], 0
    v_mov_b32_dpp v38, v50 quad_perm:[0,1,2,3] row_mask:0xf bank_mask:1
    v_add_f32_dpp v37, v31, v37 row_ror:12 row_mask:0xf bank_mask:1
    v_add_f32_dpp v36, v28, v36 row_ror:8 row_mask:0xf bank_mask:1
    v_add_f32_dpp v35, v25, v35 row_ror:4 row_mask:0xf bank_mask:1
    s_waitcnt vmcnt(3)
    s_cmp_gt_u32 s75, 2
    s_cselect_b32 s83, s83, s59
    buffer_load_dwordx4 v[248:251], v1, s[4:7], s83 offen offset:2048 nt
    s_waitcnt vmcnt(3)
    s_cmp_gt_u32 s75, 3
    s_cselect_b32 s83, s83, s59
    buffer_load_dwordx4 v[252:255], v1, s[4:7], s83 offen offset:3072 nt
    s_waitcnt vmcnt(24)
    v_mfma_f32_16x16x32_bf16 v[22:25], v[188:191], v[14:17], 0
    v_mov_b32_dpp v39, v54 quad_perm:[0,1,2,3] row_mask:0xf bank_mask:1
    v_add_f32_dpp v38, v51, v38 row_ror:12 row_mask:0xf bank_mask:1
    v_add_f32_dpp v37, v32, v37 row_ror:8 row_mask:0xf bank_mask:1
    v_add_f32_dpp v36, v29, v36 row_ror:4 row_mask:0xf bank_mask:1
    s_waitcnt vmcnt(3)
    s_add_u32 s84, s77, 0
    s_add_u32 m0, s80, 8192
    s_nop 0
    buffer_load_dwordx4 v2, s[8:11], s84 offen offset:0 nt lds
    s_waitcnt vmcnt(16)
    v_mfma_f32_16x16x32_bf16 v[26:29], v[192:195], v[14:17], 0
    v_mov_b32_dpp v40, v18 quad_perm:[0,1,2,3] row_mask:0xf bank_mask:1
    v_add_f32_dpp v39, v55, v39 row_ror:12 row_mask:0xf bank_mask:1
    v_add_f32_dpp v38, v52, v38 row_ror:8 row_mask:0xf bank_mask:1
    v_add_f32_dpp v37, v33, v37 row_ror:4 row_mask:0xf bank_mask:1
    s_waitcnt vmcnt(3)
    buffer_load_dwordx4 v3, s[8:11], s84 offen offset:1024 nt lds
    s_waitcnt vmcnt(16)
    v_mfma_f32_16x16x32_bf16 v[30:33], v[196:199], v[14:17], 0
    v_mov_b32_dpp v41, v22 quad_perm:[0,1,2,3] row_mask:0xf bank_mask:1
    v_add_f32_dpp v40, v19, v40 row_ror:12 row_mask:0xf bank_mask:1
    v_add_f32_dpp v39, v56, v39 row_ror:8 row_mask:0xf bank_mask:1
    v_add_f32_dpp v38, v53, v38 row_ror:4 row_mask:0xf bank_mask:1
    s_waitcnt vmcnt(3)
    buffer_load_dwordx4 v4, s[8:11], s84 offen offset:2048 nt lds
    s_waitcnt vmcnt(16)
    v_mfma_f32_16x16x32_bf16 v[50:53], v[200:203], v[14:17], 0
    v_mov_b32_dpp v34, v27 quad_perm:[0,1,2,3] row_mask:0xf bank_mask:2
    v_add_f32_dpp v41, v23, v41 row_ror:12 row_mask:0xf bank_mask:1
    v_add_f32_dpp v40, v20, v40 row_ror:8 row_mask:0xf bank_mask:1
    v_add_f32_dpp v39, v57, v39 row_ror:4 row_mask:0xf bank_mask:1
    s_waitcnt vmcnt(3)
    buffer_load_dwordx4 v5, s[8:11], s84 offen offset:3072 nt lds
    s_waitcnt vmcnt(16)
    v_mfma_f32_16x16x32_bf16 v[54:57], v[204:207], v[14:17], 0
    v_mov_b32_dpp v35, v31 quad_perm:[0,1,2,3] row_mask:0xf bank_mask:2
    v_add_f32_dpp v34, v28, v34 row_ror:12 row_mask:0xf bank_mask:2
    v_add_f32_dpp v41, v24, v41 row_ror:8 row_mask:0xf bank_mask:1
    v_add_f32_dpp v40, v21, v40 row_ror:4 row_mask:0xf bank_mask:1
    s_waitcnt vmcnt(3)
    s_add_u32 s84, s77, 32768
    s_add_u32 m0, s80, 12288
    s_nop 0
    buffer_load_dwordx4 v2, s[8:11], s84 offen offset:0 nt lds
    s_waitcnt vmcnt(16)
    v_mfma_f32_16x16x32_bf16 v[18:21], v[208:211], v[14:17], 0
    v_mov_b32_dpp v36, v51 quad_perm:[0,1,2,3] row_mask:0xf bank_mask:2
    v_add_f32_dpp v35, v32, v35 row_ror:12 row_mask:0xf bank_mask:2
    v_add_f32_dpp v34, v29, v34 row_ror:8 row_mask:0xf bank_mask:2
    v_add_f32_dpp v41, v25, v41 row_ror:4 row_mask:0xf bank_mask:1
    s_waitcnt vmcnt(3)
    buffer_load_dwordx4 v3, s[8:11], s84 offen offset:1024 nt lds
    s_waitcnt vmcnt(16)
    v_mfma_f32_16x16x32_bf16 v[22:25], v[212:215], v[14:17], 0
    v_mov_b32_dpp v37, v55 quad_perm:[0,1,2,3] row_mask:0xf bank_mask:2
    v_add_f32_dpp v36, v52, v36 row_ror:12 row_mask:0xf bank_mask:2
    v_add_f32_dpp v35, v33, v35 row_ror:8 row_mask:0xf bank_mask:2
    v_add_f32_dpp v34, v26, v34 row_ror:4 row_mask:0xf bank_mask:2
    s_waitcnt vmcnt(3)
    buffer_load_dwordx4 v4, s[8:11], s84 offen offset:2048 nt lds
    s_waitcnt vmcnt(16)
    v_mfma_f32_16x16x32_bf16 v[26:29], v[216:219], v[14:17], 0
    v_mov_b32_dpp v38, v19 quad_perm:[0,1,2,3] row_mask:0xf bank_mask:2
    v_add_f32_dpp v37, v56, v37 row_ror:12 row_mask:0xf bank_mask:2
    v_add_f32_dpp v36, v53, v36 row_ror:8 row_mask:0xf bank_mask:2
    v_add_f32_dpp v35, v30, v35 row_ror:4 row_mask:0xf bank_mask:2
    s_waitcnt vmcnt(3)
    buffer_load_dwordx4 v5, s[8:11], s84 offen offset:3072 nt lds
    s_waitcnt vmcnt(16)
    v_mfma_f32_16x16x32_bf16 v[30:33], v[220:223], v[14:17], 0
    v_mov_b32_dpp v39, v23 quad_perm:[0,1,2,3] row_mask:0xf bank_mask:2
    v_add_f32_dpp v38, v20, v38 row_ror:12 row_mask:0xf bank_mask:2
    v_add_f32_dpp v37, v57, v37 row_ror:8 row_mask:0xf bank_mask:2
    v_add_f32_dpp v36, v50, v36 row_ror:4 row_mask:0xf bank_mask:2
    s_waitcnt vmcnt(15)
    v_mfma_f32_16x16x32_bf16 v[50:53], v[224:227], v[14:17], 0
    v_mov_b32_dpp v40, v27 quad_perm:[0,1,2,3] row_mask:0xf bank_mask:2
    v_add_f32_dpp v39, v24, v39 row_ror:12 row_mask:0xf bank_mask:2
    v_add_f32_dpp v38, v21, v38 row_ror:8 row_mask:0xf bank_mask:2
    v_add_f32_dpp v37, v54, v37 row_ror:4 row_mask:0xf bank_mask:2
    s_waitcnt vmcnt(14)
    v_mfma_f32_16x16x32_bf16 v[54:57], v[228:231], v[14:17], 0
    v_mov_b32_dpp v41, v31 quad_perm:[0,1,2,3] row_mask:0xf bank_mask:2
    v_add_f32_dpp v40, v28, v40 row_ror:12 row_mask:0xf bank_mask:2
    v_add_f32_dpp v39, v25, v39 row_ror:8 row_mask:0xf bank_mask:2
    v_add_f32_dpp v38, v18, v38 row_ror:4 row_mask:0xf bank_mask:2
    s_waitcnt vmcnt(13)
    v_mfma_f32_16x16x32_bf16 v[18:21], v[232:235], v[14:17], 0
    v_mov_b32_dpp v34, v52 quad_perm:[0,1,2,3] row_mask:0xf bank_mask:4
    v_add_f32_dpp v41, v32, v41 row_ror:12 row_mask:0xf bank_mask:2
    v_add_f32_dpp v40, v29, v40 row_ror:8 row_mask:0xf bank_mask:2
    v_add_f32_dpp v39, v22, v39 row_ror:4 row_mask:0xf bank_mask:2
    s_waitcnt vmcnt(12)
    v_mfma_f32_16x16x32_bf16 v[22:25], v[236:239], v[14:17], 0
    v_mov_b32_dpp v35, v56 quad_perm:[0,1,2,3] row_mask:0xf bank_mask:4
    v_add_f32_dpp v34, v53, v34 row_ror:12 row_mask:0xf bank_mask:4
    v_add_f32_dpp v41, v33, v41 row_ror:8 row_mask:0xf bank_mask:2
    v_add_f32_dpp v40, v26, v40 row_ror:4 row_mask:0xf bank_mask:2
    s_waitcnt vmcnt(11)
    v_mfma_f32_16x16x32_bf16 v[26:29], v[240:243], v[14:17], 0
    v_mov_b32_dpp v36, v20 quad_perm:[0,1,2,3] row_mask:0xf bank_mask:4
    v_add_f32_dpp v35, v57, v35 row_ror:12 row_mask:0xf bank_mask:4
    v_add_f32_dpp v34, v50, v34 row_ror:8 row_mask:0xf bank_mask:4
    v_add_f32_dpp v41, v30, v41 row_ror:4 row_mask:0xf bank_mask:2
    s_waitcnt vmcnt(10)
    v_mfma_f32_16x16x32_bf16 v[30:33], v[244:247], v[14:17], 0
    v_mov_b32_dpp v37, v24 quad_perm:[0,1,2,3] row_mask:0xf bank_mask:4
    v_add_f32_dpp v36, v21, v36 row_ror:12 row_mask:0xf bank_mask:4
    v_add_f32_dpp v35, v54, v35 row_ror:8 row_mask:0xf bank_mask:4
    v_add_f32_dpp v34, v51, v34 row_ror:4 row_mask:0xf bank_mask:4
    s_waitcnt vmcnt(9)
    v_mfma_f32_16x16x32_bf16 v[50:53], v[248:251], v[14:17], 0
    v_mov_b32_dpp v38, v28 quad_perm:[0,1,2,3] row_mask:0xf bank_mask:4
    v_add_f32_dpp v37, v25, v37 row_ror:12 row_mask:0xf bank_mask:4
    v_add_f32_dpp v36, v18, v36 row_ror:8 row_mask:0xf bank_mask:4
    v_add_f32_dpp v35, v55, v35 row_ror:4 row_mask:0xf bank_mask:4
    s_waitcnt vmcnt(8)
    v_mfma_f32_16x16x32_bf16 v[54:57], v[252:255], v[14:17], 0
    v_mov_b32_dpp v39, v32 quad_perm:[0,1,2,3] row_mask:0xf bank_mask:4
    v_add_f32_dpp v38, v29, v38 row_ror:12 row_mask:0xf bank_mask:4
    v_add_f32_dpp v37, v22, v37 row_ror:8 row_mask:0xf bank_mask:4
    v_add_f32_dpp v36, v19, v36 row_ror:4 row_mask:0xf bank_mask:4
    s_nop 0
    v_mov_b32_dpp v40, v52 quad_perm:[0,1,2,3] row_mask:0xf bank_mask:4
    v_add_f32_dpp v39, v33, v39 row_ror:12 row_mask:0xf bank_mask:4
    v_add_f32_dpp v38, v26, v38 row_ror:8 row_mask:0xf bank_mask:4
    v_add_f32_dpp v37, v23, v37 row_ror:4 row_mask:0xf bank_mask:4
    s_nop 0
    v_mov_b32_dpp v41, v56 quad_perm:[0,1,2,3] row_mask:0xf bank_mask:4
    v_add_f32_dpp v40, v53, v40 row_ror:12 row_mask:0xf bank_mask:4
    v_add_f32_dpp v39, v30, v39 row_ror:8 row_mask:0xf bank_mask:4
    v_add_f32_dpp v38, v27, v38 row_ror:4 row_mask:0xf bank_mask:4
    s_nop 0
    s_nop 0
    v_add_f32_dpp v41, v57, v41 row_ror:12 row_mask:0xf bank_mask:4
    v_add_f32_dpp v40, v50, v40 row_ror:8 row_mask:0xf bank_mask:4
    v_add_f32_dpp v39, v31, v39 row_ror:4 row_mask:0xf bank_mask:4
    s_nop 0
    s_nop 0
    s_nop 0
    v_add_f32_dpp v41, v54, v41 row_ror:8 row_mask:0xf bank_mask:4
    v_add_f32_dpp v40, v51, v40 row_ror:4 row_mask:0xf bank_mask:4
    s_nop 0
    s_nop 0
    s_nop 0
    s_nop 0
    v_add_f32_dpp v41, v55, v41 row_ror:4 row_mask:0xf bank_mask:4
    s_nop 0
    s_nop 0
    s_nop 0
    s_nop 0
    s_nop 0
    v_mov_b32 v50, 0xff7fffff
    s_cmp_gt_u32 s75, 1
    s_cselect_b32 s86, 0, 0xf000f00
    s_cselect_b32 s87, 0, 0xf000f00
    v_cndmask_b32 v39, v39, v50, s[86:87]
    s_cmp_gt_u32 s75, 2
    s_cselect_b32 s86, 0, 0xf000f00
    s_cselect_b32 s87, 0, 0xf000f00
    v_cndmask_b32 v40, v40, v50, s[86:87]
    s_cmp_gt_u32 s75, 3
    s_cselect_b32 s86, 0, 0xf000f00
    s_cselect_b32 s87, 0, 0xf000f00
    v_cndmask_b32 v41, v41, v50, s[86:87]
    s_mov_b32 s86, 1035273459
    s_mov_b32 s87, 1069066811
    s_mov_b32 s88, 0xffff0000
    v_cvt_pk_bf16_f32 v50, v34, v35
    v_lshlrev_b32 v34, 16, v50
    v_and_b32 v35, s88, v50
    v_mul_f32 v34, s86, v34
    v_mul_f32 v35, s86, v35
    v_cvt_pk_bf16_f32 v50, v34, v35
    v_lshlrev_b32 v34, 16, v50
    v_and_b32 v35, s88, v50
    v_cvt_pk_bf16_f32 v51, v36, v37
    v_lshlrev_b32 v36, 16, v51
    v_and_b32 v37, s88, v51
    v_mul_f32 v36, s86, v36
    v_mul_f32 v37, s86, v37
    v_cvt_pk_bf16_f32 v51, v36, v37
    v_lshlrev_b32 v36, 16, v51
    v_and_b32 v37, s88, v51
    v_cvt_pk_bf16_f32 v52, v38, v39
    v_lshlrev_b32 v38, 16, v52
    v_and_b32 v39, s88, v52
    v_mul_f32 v38, s86, v38
    v_mul_f32 v39, s86, v39
    v_cvt_pk_bf16_f32 v52, v38, v39
    v_lshlrev_b32 v38, 16, v52
    v_and_b32 v39, s88, v52
    v_cvt_pk_bf16_f32 v53, v40, v41
    v_lshlrev_b32 v40, 16, v53
    v_and_b32 v41, s88, v53
    v_mul_f32 v40, s86, v40
    v_mul_f32 v41, s86, v41
    v_cvt_pk_bf16_f32 v53, v40, v41
    v_lshlrev_b32 v40, 16, v53
    v_and_b32 v41, s88, v53
    v_max3_f32 v50, v34, v35, v36
    v_max3_f32 v50, v50, v37, v60
    v_max3_f32 v51, v38, v39, v40
    v_max3_f32 v50, v50, v51, v41
    s_nop 1
    v_max_f32_dpp v50, v50, v50 row_ror:4 row_mask:0xf bank_mask:0xf
    s_nop 1
    v_max_f32_dpp v50, v50, v50 row_ror:8 row_mask:0xf bank_mask:0xf
    v_mov_b32 v51, v50
    s_nop 1
    v_permlane16_swap_b32 v50, v51
    v_max_f32 v50, v50, v51
    v_mov_b32 v51, v50
    s_nop 1
    v_permlane32_swap_b32 v50, v51
    v_max_f32 v50, v50, v51
    v_sub_f32 v53, v60, v50
    v_mul_f32 v53, s87, v53
    v_exp_f32 v53, v53
    v_mul_f32 v52, s87, v50
    v_sub_f32 v52, 0, v52
    v_fma_f32 v34, v34, s87, v52
    v_fma_f32 v35, v35, s87, v52
    v_fma_f32 v36, v36, s87, v52
    v_fma_f32 v37, v37, s87, v52
    v_fma_f32 v38, v38, s87, v52
    v_fma_f32 v39, v39, s87, v52
    v_fma_f32 v40, v40, s87, v52
    v_fma_f32 v41, v41, s87, v52
    v_exp_f32 v34, v34
    v_exp_f32 v35, v35
    v_exp_f32 v36, v36
    v_exp_f32 v37, v37
    v_exp_f32 v38, v38
    v_exp_f32 v39, v39
    v_exp_f32 v40, v40
    v_exp_f32 v41, v41
    v_mul_f32 v51, v61, v53
    v_mul_f32 v64, v64, v53
    v_mul_f32 v65, v65, v53
    v_mul_f32 v66, v66, v53
    v_mul_f32 v67, v67, v53
    v_mul_f32 v68, v68, v53
    v_mul_f32 v69, v69, v53
    v_mul_f32 v70, v70, v53
    v_mul_f32 v71, v71, v53
    v_mul_f32 v72, v72, v53
    v_mul_f32 v73, v73, v53
    v_mul_f32 v74, v74, v53
    v_mul_f32 v75, v75, v53
    v_mul_f32 v76, v76, v53
    v_mul_f32 v77, v77, v53
    v_mul_f32 v78, v78, v53
    v_mul_f32 v79, v79, v53
    v_mul_f32 v80, v80, v53
    v_mul_f32 v81, v81, v53
    v_mul_f32 v82, v82, v53
    v_mul_f32 v83, v83, v53
    v_mul_f32 v84, v84, v53
    v_mul_f32 v85, v85, v53
    v_mul_f32 v86, v86, v53
    v_mul_f32 v87, v87, v53
    v_mul_f32 v88, v88, v53
    v_mul_f32 v89, v89, v53
    v_mul_f32 v90, v90, v53
    v_mul_f32 v91, v91, v53
    v_mul_f32 v92, v92, v53
    v_mul_f32 v93, v93, v53
    v_mul_f32 v94, v94, v53
    v_mul_f32 v95, v95, v53
    v_cvt_pk_bf16_f32 v18, v34, v35
    v_cvt_pk_bf16_f32 v19, v36, v37
    v_cvt_pk_bf16_f32 v20, v38, v39
    v_cvt_pk_bf16_f32 v21, v40, v41
    v_add_f32 v51, v51, v34
    v_add_f32 v51, v51, v35
    v_add_f32 v51, v51, v36
    v_add_f32 v51, v51, v37
    v_add_f32 v51, v51, v38
    v_add_f32 v51, v51, v39
    v_add_f32 v51, v51, v40
    v_add_f32 v51, v51, v41
    s_nop 1
    v_add_f32_dpp v51, v51, v51 row_ror:4 row_mask:0xf bank_mask:0xf
    s_nop 1
    v_add_f32_dpp v51, v51, v51 row_ror:8 row_mask:0xf bank_mask:0xf
    v_mov_b32 v53, v51
    s_nop 1
    v_permlane16_swap_b32 v51, v53
    v_add_f32 v51, v51, v53
    v_mov_b32 v53, v51
    s_nop 1
    v_permlane32_swap_b32 v51, v53
    v_add_f32 v51, v51, v53
    s_mov_b32 s69, 6
    s_branch L_stats
L_stats_ret_6:
    ds_read_b64_tr_b16 v[96:97], v6 offset:0
    ds_read_b64_tr_b16 v[100:101], v7 offset:0
    ds_read_b64_tr_b16 v[104:105], v8 offset:0
    ds_read_b64_tr_b16 v[108:109], v9 offset:0
    ds_read_b64_tr_b16 v[112:113], v10 offset:0
    ds_read_b64_tr_b16 v[116:117], v11 offset:0
    ds_read_b64_tr_b16 v[120:121], v12 offset:0
    ds_read_b64_tr_b16 v[124:125], v13 offset:0
    s_waitcnt lgkmcnt(0)
    s_waitcnt vmcnt(7)
    s_add_u32 s84, s77, 65536
    s_add_u32 m0, s80, 0
    s_nop 0
    buffer_load_dwordx4 v2, s[8:11], s84 offen offset:0 nt lds
    s_waitcnt vmcnt(7)
    buffer_load_dwordx4 v3, s[8:11], s84 offen offset:1024 nt lds
    s_waitcnt vmcnt(7)
    buffer_load_dwordx4 v4, s[8:11], s84 offen offset:2048 nt lds
    s_waitcnt vmcnt(7)
    buffer_load_dwordx4 v5, s[8:11], s84 offen offset:3072 nt lds
    ds_read_b64_tr_b16 v[98:99], v6 offset:4096
    ds_read_b64_tr_b16 v[102:103], v7 offset:4096
    ds_read_b64_tr_b16 v[106:107], v8 offset:4096
    ds_read_b64_tr_b16 v[110:111], v9 offset:4096
    ds_read_b64_tr_b16 v[114:115], v10 offset:4096
    ds_read_b64_tr_b16 v[118:119], v11 offset:4096
    ds_read_b64_tr_b16 v[122:123], v12 offset:4096
    ds_read_b64_tr_b16 v[126:127], v13 offset:4096
    s_waitcnt lgkmcnt(0)
    s_waitcnt vmcnt(7)
    s_mov_b32 s84, s76
    s_add_u32 m0, s80, 4096
    s_nop 0
    buffer_load_dwordx4 v2, s[8:11], s84 offen offset:0 nt lds
    s_waitcnt vmcnt(7)
    s_cmp_gt_u32 s75, 1
    s_cselect_b32 s84, s84, s59
    buffer_load_dwordx4 v3, s[8:11], s84 offen offset:1024 nt lds
    s_waitcnt vmcnt(7)
    s_cmp_gt_u32 s75, 2
    s_cselect_b32 s84, s84, s59
    buffer_load_dwordx4 v4, s[8:11], s84 offen offset:2048 nt lds
    s_waitcnt vmcnt(7)
    s_cmp_gt_u32 s75, 3
    s_cselect_b32 s84, s84, s59
    buffer_load_dwordx4 v5, s[8:11], s84 offen offset:3072 nt lds
    v_mfma_f32_16x16x32_bf16 v[64:67], v[96:99], v[18:21], v[64:67]
    v_mfma_f32_16x16x32_bf16 v[68:71], v[100:103], v[18:21], v[68:71]
    v_mfma_f32_16x16x32_bf16 v[72:75], v[104:107], v[18:21], v[72:75]
    v_mfma_f32_16x16x32_bf16 v[76:79], v[108:111], v[18:21], v[76:79]
    v_mfma_f32_16x16x32_bf16 v[80:83], v[112:115], v[18:21], v[80:83]
    v_mfma_f32_16x16x32_bf16 v[84:87], v[116:119], v[18:21], v[84:87]
    v_mfma_f32_16x16x32_bf16 v[88:91], v[120:123], v[18:21], v[88:91]
    v_mfma_f32_16x16x32_bf16 v[92:95], v[124:127], v[18:21], v[92:95]
    v_mov_b32_dpp v30, v18 row_ror:12 row_mask:0xf bank_mask:0xf
    v_mov_b32_dpp v31, v19 row_ror:12 row_mask:0xf bank_mask:0xf
    v_mov_b32_dpp v32, v20 row_ror:12 row_mask:0xf bank_mask:0xf
    v_mov_b32_dpp v33, v21 row_ror:12 row_mask:0xf bank_mask:0xf
    s_waitcnt vmcnt(12)
    ds_read_b64_tr_b16 v[128:129], v6 offset:8192
    ds_read_b64_tr_b16 v[132:133], v7 offset:8192
    ds_read_b64_tr_b16 v[136:137], v8 offset:8192
    ds_read_b64_tr_b16 v[140:141], v9 offset:8192
    ds_read_b64_tr_b16 v[144:145], v10 offset:8192
    ds_read_b64_tr_b16 v[148:149], v11 offset:8192
    ds_read_b64_tr_b16 v[152:153], v12 offset:8192
    ds_read_b64_tr_b16 v[156:157], v13 offset:8192
    s_waitcnt vmcnt(8)
    ds_read_b64_tr_b16 v[130:131], v6 offset:12288
    ds_read_b64_tr_b16 v[134:135], v7 offset:12288
    ds_read_b64_tr_b16 v[138:139], v8 offset:12288
    ds_read_b64_tr_b16 v[142:143], v9 offset:12288
    ds_read_b64_tr_b16 v[146:147], v10 offset:12288
    ds_read_b64_tr_b16 v[150:151], v11 offset:12288
    ds_read_b64_tr_b16 v[154:155], v12 offset:12288
    ds_read_b64_tr_b16 v[158:159], v13 offset:12288
    s_waitcnt lgkmcnt(7)
    v_mfma_f32_16x16x32_bf16 v[64:67], v[128:131], v[30:33], v[64:67]
    s_waitcnt lgkmcnt(6)
    v_mfma_f32_16x16x32_bf16 v[68:71], v[132:135], v[30:33], v[68:71]
    s_waitcnt lgkmcnt(5)
    v_mfma_f32_16x16x32_bf16 v[72:75], v[136:139], v[30:33], v[72:75]
    s_waitcnt lgkmcnt(4)
    v_mfma_f32_16x16x32_bf16 v[76:79], v[140:143], v[30:33], v[76:79]
    s_waitcnt lgkmcnt(3)
    v_mfma_f32_16x16x32_bf16 v[80:83], v[144:147], v[30:33], v[80:83]
    s_waitcnt lgkmcnt(2)
    v_mfma_f32_16x16x32_bf16 v[84:87], v[148:151], v[30:33], v[84:87]
    s_waitcnt lgkmcnt(1)
    v_mfma_f32_16x16x32_bf16 v[88:91], v[152:155], v[30:33], v[88:91]
    s_waitcnt lgkmcnt(0)
    v_mfma_f32_16x16x32_bf16 v[92:95], v[156:159], v[30:33], v[92:95]
    v_mov_b32_dpp v26, v18 row_ror:8 row_mask:0xf bank_mask:0xf
    v_mov_b32_dpp v27, v19 row_ror:8 row_mask:0xf bank_mask:0xf
    v_mov_b32_dpp v28, v20 row_ror:8 row_mask:0xf bank_mask:0xf
    v_mov_b32_dpp v29, v21 row_ror:8 row_mask:0xf bank_mask:0xf
    s_waitcnt vmcnt(4)
    ds_read_b64_tr_b16 v[96:97], v6 offset:0
    ds_read_b64_tr_b16 v[100:101], v7 offset:0
    ds_read_b64_tr_b16 v[104:105], v8 offset:0
    ds_read_b64_tr_b16 v[108:109], v9 offset:0
    ds_read_b64_tr_b16 v[112:113], v10 offset:0
    ds_read_b64_tr_b16 v[116:117], v11 offset:0
    ds_read_b64_tr_b16 v[120:121], v12 offset:0
    ds_read_b64_tr_b16 v[124:125], v13 offset:0
    s_waitcnt vmcnt(0)
    ds_read_b64_tr_b16 v[98:99], v6 offset:4096
    ds_read_b64_tr_b16 v[102:103], v7 offset:4096
    ds_read_b64_tr_b16 v[106:107], v8 offset:4096
    ds_read_b64_tr_b16 v[110:111], v9 offset:4096
    ds_read_b64_tr_b16 v[114:115], v10 offset:4096
    ds_read_b64_tr_b16 v[118:119], v11 offset:4096
    ds_read_b64_tr_b16 v[122:123], v12 offset:4096
    ds_read_b64_tr_b16 v[126:127], v13 offset:4096
    s_waitcnt lgkmcnt(7)
    v_mfma_f32_16x16x32_bf16 v[64:67], v[96:99], v[26:29], v[64:67]
    s_waitcnt lgkmcnt(6)
    v_mfma_f32_16x16x32_bf16 v[68:71], v[100:103], v[26:29], v[68:71]
    s_waitcnt lgkmcnt(5)
    v_mfma_f32_16x16x32_bf16 v[72:75], v[104:107], v[26:29], v[72:75]
    s_waitcnt lgkmcnt(4)
    v_mfma_f32_16x16x32_bf16 v[76:79], v[108:111], v[26:29], v[76:79]
    s_waitcnt lgkmcnt(3)
    v_mfma_f32_16x16x32_bf16 v[80:83], v[112:115], v[26:29], v[80:83]
    s_waitcnt lgkmcnt(2)
    v_mfma_f32_16x16x32_bf16 v[84:87], v[116:119], v[26:29], v[84:87]
    s_waitcnt lgkmcnt(1)
    v_mfma_f32_16x16x32_bf16 v[88:91], v[120:123], v[26:29], v[88:91]
    s_waitcnt lgkmcnt(0)
    v_mfma_f32_16x16x32_bf16 v[92:95], v[124:127], v[26:29], v[92:95]
    s_branch L_vdone
L_prodq_pre:
    s_mov_b32 s48, s22
    s_and_b32 s49, s23, 0xffff
    s_mov_b32 s50, 4194304
    s_mov_b32 s51, 0x20000
    v_lshl_add_u32 v61, v58, 13, v59
    s_sub_u32 s86, s3, 4
    s_lshl_b32 s86, s86, 20
    s_lshl_b32 s87, s43, 7
    s_add_u32 s86, s86, s87
    s_add_u32 m0, s80, 0
    s_nop 0
    buffer_load_dwordx4 v61, s[48:51], s86 offen nt lds
    s_add_u32 m0, s80, 1024
    s_add_u32 s86, s86, 65536
    buffer_load_dwordx4 v61, s[48:51], s86 offen nt lds
    s_add_u32 m0, s80, 2048
    s_add_u32 s86, s86, 65536
    buffer_load_dwordx4 v61, s[48:51], s86 offen nt lds
    s_add_u32 m0, s80, 3072
    s_add_u32 s86, s86, 65536
    buffer_load_dwordx4 v61, s[48:51], s86 offen nt lds
    s_add_u32 m0, s80, 4096
    s_add_u32 s86, s86, 65536
    buffer_load_dwordx4 v61, s[48:51], s86 offen nt lds
    s_add_u32 m0, s80, 5120
    s_add_u32 s86, s86, 65536
    buffer_load_dwordx4 v61, s[48:51], s86 offen nt lds
    s_add_u32 m0, s80, 6144
    s_add_u32 s86, s86, 65536
    buffer_load_dwordx4 v61, s[48:51], s86 offen nt lds
    s_add_u32 m0, s80, 7168
    s_add_u32 s86, s86, 65536
    buffer_load_dwordx4 v61, s[48:51], s86 offen nt lds
    s_add_u32 m0, s80, 8192
    s_add_u32 s86, s86, 65536
    buffer_load_dwordx4 v61, s[48:51], s86 offen nt lds
    s_add_u32 m0, s80, 9216
    s_add_u32 s86, s86, 65536
    buffer_load_dwordx4 v61, s[48:51], s86 offen nt lds
    s_add_u32 m0, s80, 10240
    s_add_u32 s86, s86, 65536
    buffer_load_dwordx4 v61, s[48:51], s86 offen nt lds
    s_add_u32 m0, s80, 11264
    s_add_u32 s86, s86, 65536
    buffer_load_dwordx4 v61, s[48:51], s86 offen nt lds
    s_add_u32 m0, s80, 12288
    s_add_u32 s86, s86, 65536
    buffer_load_dwordx4 v61, s[48:51], s86 offen nt lds
    s_add_u32 m0, s80, 13312
    s_add_u32 s86, s86, 65536
    buffer_load_dwordx4 v61, s[48:51], s86 offen nt lds
    s_add_u32 m0, s80, 14336
    s_add_u32 s86, s86, 65536
    buffer_load_dwordx4 v61, s[48:51], s86 offen nt lds
    s_add_u32 m0, s80, 15360
    s_add_u32 s86, s86, 65536
    buffer_load_dwordx4 v61, s[48:51], s86 offen nt lds
    s_mov_b32 s64, s16
    s_and_b32 s65, s17, 0xffff
    s_mov_b32 s66, 8192
    s_mov_b32 s67, 0x20000
    v_and_b32 v60, 7, v0
    v_lshlrev_b32 v60, 10, v60
    v_lshl_add_u32 v60, v52, 4, v60
    s_lshl_b32 s86, s3, 8
    s_sub_u32 s86, s86, 1024
    buffer_load_dwordx4 v[192:195], v60, s[64:67], s86 offen offset:0
    buffer_load_dwordx4 v[196:199], v60, s[64:67], s86 offen offset:64
    buffer_load_dwordx4 v[200:203], v60, s[64:67], s86 offen offset:128
    buffer_load_dwordx4 v[204:207], v60, s[64:67], s86 offen offset:192
    s_branch L_bar0
L_prodg_pre:
    s_mov_b32 s48, s28
    s_and_b32 s49, s29, 0xffff
    s_mov_b32 s50, 1835008
    s_mov_b32 s51, 0x20000
    s_mov_b32 s52, s30
    s_and_b32 s53, s31, 0xffff
    s_mov_b32 s54, 1835008
    s_mov_b32 s55, 0x20000
    v_lshrrev_b32 v61, 2, v0
    v_mul_u32_u24 v61, 3584, v61
    v_lshl_add_u32 v61, v50, 4, v61
    s_sub_u32 s86, s3, 4
    s_mul_i32 s86, s86, 458752
    s_lshl_b32 s87, s42, 6
    s_add_u32 s86, s86, s87
    s_mov_b32 s88, s86
    s_add_u32 m0, s80, 0
    s_nop 0
    buffer_load_dwordx4 v61, s[48:51], s86 offen nt lds
    s_add_u32 m0, s80, 1024
    s_add_u32 s86, s86, 57344
    buffer_load_dwordx4 v61, s[48:51], s86 offen nt lds
    s_add_u32 m0, s80, 2048
    s_add_u32 s86, s86, 57344
    buffer_load_dwordx4 v61, s[48:51], s86 offen nt lds
    s_add_u32 m0, s80, 3072
    s_add_u32 s86, s86, 57344
    buffer_load_dwordx4 v61, s[48:51], s86 offen nt lds
    s_add_u32 m0, s80, 4096
    s_add_u32 s86, s86, 57344
    buffer_load_dwordx4 v61, s[48:51], s86 offen nt lds
    s_add_u32 m0, s80, 5120
    s_add_u32 s86, s86, 57344
    buffer_load_dwordx4 v61, s[48:51], s86 offen nt lds
    s_add_u32 m0, s80, 6144
    s_add_u32 s86, s86, 57344
    buffer_load_dwordx4 v61, s[48:51], s86 offen nt lds
    s_add_u32 m0, s80, 7168
    s_add_u32 s86, s86, 57344
    buffer_load_dwordx4 v61, s[48:51], s86 offen nt lds
    s_add_u32 m0, s80, 8192
    s_nop 0
    buffer_load_dwordx4 v61, s[52:55], s88 offen nt lds
    s_add_u32 m0, s80, 9216
    s_add_u32 s88, s88, 57344
    buffer_load_dwordx4 v61, s[52:55], s88 offen nt lds
    s_add_u32 m0, s80, 10240
    s_add_u32 s88, s88, 57344
    buffer_load_dwordx4 v61, s[52:55], s88 offen nt lds
    s_add_u32 m0, s80, 11264
    s_add_u32 s88, s88, 57344
    buffer_load_dwordx4 v61, s[52:55], s88 offen nt lds
    s_add_u32 m0, s80, 12288
    s_add_u32 s88, s88, 57344
    buffer_load_dwordx4 v61, s[52:55], s88 offen nt lds
    s_add_u32 m0, s80, 13312
    s_add_u32 s88, s88, 57344
    buffer_load_dwordx4 v61, s[52:55], s88 offen nt lds
    s_add_u32 m0, s80, 14336
    s_add_u32 s88, s88, 57344
    buffer_load_dwordx4 v61, s[52:55], s88 offen nt lds
    s_add_u32 m0, s80, 15360
    s_add_u32 s88, s88, 57344
    buffer_load_dwordx4 v61, s[52:55], s88 offen nt lds
    s_mov_b32 s64, s16
    s_and_b32 s65, s17, 0xffff
    s_mov_b32 s66, 8192
    s_mov_b32 s67, 0x20000
    v_and_b32 v60, 7, v0
    v_lshlrev_b32 v60, 10, v60
    v_lshl_add_u32 v60, v52, 4, v60
    s_lshl_b32 s86, s3, 8
    s_sub_u32 s86, s86, 1024
    buffer_load_dwordx4 v[192:195], v60, s[64:67], s86 offen offset:0
    buffer_load_dwordx4 v[196:199], v60, s[64:67], s86 offen offset:64
    buffer_load_dwordx4 v[200:203], v60, s[64:67], s86 offen offset:128
    buffer_load_dwordx4 v[204:207], v60, s[64:67], s86 offen offset:192
    s_branch L_bar0
L_prod:
    s_add_u32 s83, s81, 0
    buffer_load_dwordx4 v[64:67], v1, s[4:7], s83 offen offset:0 nt
    buffer_load_dwordx4 v[68:71], v1, s[4:7], s83 offen offset:1024 nt
    buffer_load_dwordx4 v[72:75], v1, s[4:7], s83 offen offset:2048 nt
    buffer_load_dwordx4 v[76:79], v1, s[4:7], s83 offen offset:3072 nt
    v_add_u32 v40, s80, v62
    v_lshrrev_b32 v41, 1, v62
    v_lshl_add_u32 v41, v50, 2, v41
    v_add_u32 v41, s80, v41
    v_lshlrev_b32 v42, 4, v0
    v_add_u32 v43, s80, v42
    v_mov_b32 v44, 147464
    v_mov_b32 v45, 1
    v_add_u32 v42, 65536, v42
    s_waitcnt vmcnt(4)
    s_cmp_eq_u32 s91, 1
    s_cbranch_scc1 L_prod_g
    ds_read_b64_tr_b16 v[224:225], v40 offset:0
    ds_read_b64_tr_b16 v[226:227], v40 offset:512
    ds_read_b64_tr_b16 v[228:229], v40 offset:32
    ds_read_b64_tr_b16 v[230:231], v40 offset:544
    ds_read_b64_tr_b16 v[232:233], v40 offset:64
    ds_read_b64_tr_b16 v[234:235], v40 offset:576
    ds_read_b64_tr_b16 v[236:237], v40 offset:96
    ds_read_b64_tr_b16 v[238:239], v40 offset:608
    s_waitcnt lgkmcnt(6)
    v_mfma_f32_16x16x32_bf16 v[208:211], v[224:227], v[192:195], 0
    s_waitcnt lgkmcnt(4)
    v_mfma_f32_16x16x32_bf16 v[212:215], v[228:231], v[192:195], 0
    s_waitcnt lgkmcnt(2)
    v_mfma_f32_16x16x32_bf16 v[216:219], v[232:235], v[192:195], 0
    s_waitcnt lgkmcnt(0)
    v_mfma_f32_16x16x32_bf16 v[220:223], v[236:239], v[192:195], 0
    ds_read_b64_tr_b16 v[240:241], v40 offset:4096
    ds_read_b64_tr_b16 v[242:243], v40 offset:4608
    ds_read_b64_tr_b16 v[244:245], v40 offset:4128
    ds_read_b64_tr_b16 v[246:247], v40 offset:4640
    ds_read_b64_tr_b16 v[248:249], v40 offset:4160
    ds_read_b64_tr_b16 v[250:251], v40 offset:4672
    ds_read_b64_tr_b16 v[252:253], v40 offset:4192
    ds_read_b64_tr_b16 v[254:255], v40 offset:4704
    s_waitcnt lgkmcnt(6)
    v_mfma_f32_16x16x32_bf16 v[208:211], v[240:243], v[196:199], v[208:211]
    s_waitcnt lgkmcnt(4)
    v_mfma_f32_16x16x32_bf16 v[212:215], v[244:247], v[196:199], v[212:215]
    s_waitcnt lgkmcnt(2)
    v_mfma_f32_16x16x32_bf16 v[216:219], v[248:251], v[196:199], v[216:219]
    s_waitcnt lgkmcnt(0)
    v_mfma_f32_16x16x32_bf16 v[220:223], v[252:255], v[196:199], v[220:223]
    ds_read_b64_tr_b16 v[224:225], v40 offset:8192
    ds_read_b64_tr_b16 v[226:227], v40 offset:8704
    ds_read_b64_tr_b16 v[228:229], v40 offset:8224
    ds_read_b64_tr_b16 v[230:231], v40 offset:8736
    ds_read_b64_tr_b16 v[232:233], v40 offset:8256
    ds_read_b64_tr_b16 v[234:235], v40 offset:8768
    ds_read_b64_tr_b16 v[236:237], v40 offset:8288
    ds_read_b64_tr_b16 v[238:239], v40 offset:8800
    s_waitcnt lgkmcnt(6)
    v_mfma_f32_16x16x32_bf16 v[208:211], v[224:227], v[200:203], v[208:211]
    s_waitcnt lgkmcnt(4)
    v_mfma_f32_16x16x32_bf16 v[212:215], v[228:231], v[200:203], v[212:215]
    s_waitcnt lgkmcnt(2)
    v_mfma_f32_16x16x32_bf16 v[216:219], v[232:235], v[200:203], v[216:219]
    s_waitcnt lgkmcnt(0)
    v_mfma_f32_16x16x32_bf16 v[220:223], v[236:239], v[200:203], v[220:223]
    ds_read_b64_tr_b16 v[240:241], v40 offset:12288
    ds_read_b64_tr_b16 v[242:243], v40 offset:12800
    ds_read_b64_tr_b16 v[244:245], v40 offset:12320
    ds_read_b64_tr_b16 v[246:247], v40 offset:12832
    ds_read_b64_tr_b16 v[248:249], v40 offset:12352
    ds_read_b64_tr_b16 v[250:251], v40 offset:12864
    ds_read_b64_tr_b16 v[252:253], v40 offset:12384
    ds_read_b64_tr_b16 v[254:255], v40 offset:12896
    s_waitcnt lgkmcnt(6)
    v_mfma_f32_16x16x32_bf16 v[208:211], v[240:243], v[204:207], v[208:211]
    s_waitcnt lgkmcnt(4)
    v_mfma_f32_16x16x32_bf16 v[212:215], v[244:247], v[204:207], v[212:215]
    s_waitcnt lgkmcnt(2)
    v_mfma_f32_16x16x32_bf16 v[216:219], v[248:251], v[204:207], v[216:219]
    s_waitcnt lgkmcnt(0)
    v_mfma_f32_16x16x32_bf16 v[220:223], v[252:255], v[204:207], v[220:223]
    s_branch L_prod_red
L_prod_g:
    ds_read_b64_tr_b16 v[224:225], v41 offset:0
    ds_read_b64_tr_b16 v[226:227], v41 offset:256
    ds_read_b64_tr_b16 v[228:229], v41 offset:32
    ds_read_b64_tr_b16 v[230:231], v41 offset:288
    ds_read_b64_tr_b16 v[232:233], v41 offset:8192
    ds_read_b64_tr_b16 v[234:235], v41 offset:8448
    ds_read_b64_tr_b16 v[236:237], v41 offset:8224
    ds_read_b64_tr_b16 v[238:239], v41 offset:8480
    s_waitcnt lgkmcnt(6)
    v_mfma_f32_16x16x32_bf16 v[208:211], v[224:227], v[192:195], 0
    s_waitcnt lgkmcnt(4)
    v_mfma_f32_16x16x32_bf16 v[212:215], v[228:231], v[192:195], 0
    s_waitcnt lgkmcnt(2)
    v_mfma_f32_16x16x32_bf16 v[216:219], v[232:235], v[192:195], 0
    s_waitcnt lgkmcnt(0)
    v_mfma_f32_16x16x32_bf16 v[220:223], v[236:239], v[192:195], 0
    ds_read_b64_tr_b16 v[240:241], v41 offset:2048
    ds_read_b64_tr_b16 v[242:243], v41 offset:2304
    ds_read_b64_tr_b16 v[244:245], v41 offset:2080
    ds_read_b64_tr_b16 v[246:247], v41 offset:2336
    ds_read_b64_tr_b16 v[248:249], v41 offset:10240
    ds_read_b64_tr_b16 v[250:251], v41 offset:10496
    ds_read_b64_tr_b16 v[252:253], v41 offset:10272
    ds_read_b64_tr_b16 v[254:255], v41 offset:10528
    s_waitcnt lgkmcnt(6)
    v_mfma_f32_16x16x32_bf16 v[208:211], v[240:243], v[196:199], v[208:211]
    s_waitcnt lgkmcnt(4)
    v_mfma_f32_16x16x32_bf16 v[212:215], v[244:247], v[196:199], v[212:215]
    s_waitcnt lgkmcnt(2)
    v_mfma_f32_16x16x32_bf16 v[216:219], v[248:251], v[196:199], v[216:219]
    s_waitcnt lgkmcnt(0)
    v_mfma_f32_16x16x32_bf16 v[220:223], v[252:255], v[196:199], v[220:223]
    ds_read_b64_tr_b16 v[224:225], v41 offset:4096
    ds_read_b64_tr_b16 v[226:227], v41 offset:4352
    ds_read_b64_tr_b16 v[228:229], v41 offset:4128
    ds_read_b64_tr_b16 v[230:231], v41 offset:4384
    ds_read_b64_tr_b16 v[232:233], v41 offset:12288
    ds_read_b64_tr_b16 v[234:235], v41 offset:12544
    ds_read_b64_tr_b16 v[236:237], v41 offset:12320
    ds_read_b64_tr_b16 v[238:239], v41 offset:12576
    s_waitcnt lgkmcnt(6)
    v_mfma_f32_16x16x32_bf16 v[208:211], v[224:227], v[200:203], v[208:211]
    s_waitcnt lgkmcnt(4)
    v_mfma_f32_16x16x32_bf16 v[212:215], v[228:231], v[200:203], v[212:215]
    s_waitcnt lgkmcnt(2)
    v_mfma_f32_16x16x32_bf16 v[216:219], v[232:235], v[200:203], v[216:219]
    s_waitcnt lgkmcnt(0)
    v_mfma_f32_16x16x32_bf16 v[220:223], v[236:239], v[200:203], v[220:223]
    ds_read_b64_tr_b16 v[240:241], v41 offset:6144
    ds_read_b64_tr_b16 v[242:243], v41 offset:6400
    ds_read_b64_tr_b16 v[244:245], v41 offset:6176
    ds_read_b64_tr_b16 v[246:247], v41 offset:6432
    ds_read_b64_tr_b16 v[248:249], v41 offset:14336
    ds_read_b64_tr_b16 v[250:251], v41 offset:14592
    ds_read_b64_tr_b16 v[252:253], v41 offset:14368
    ds_read_b64_tr_b16 v[254:255], v41 offset:14624
    s_waitcnt lgkmcnt(6)
    v_mfma_f32_16x16x32_bf16 v[208:211], v[240:243], v[204:207], v[208:211]
    s_waitcnt lgkmcnt(4)
    v_mfma_f32_16x16x32_bf16 v[212:215], v[244:247], v[204:207], v[212:215]
    s_waitcnt lgkmcnt(2)
    v_mfma_f32_16x16x32_bf16 v[216:219], v[248:251], v[204:207], v[216:219]
    s_waitcnt lgkmcnt(0)
    v_mfma_f32_16x16x32_bf16 v[220:223], v[252:255], v[204:207], v[220:223]
L_prod_red:
    s_nop 4
    ds_write_b128 v43, v[208:211] offset:0
    ds_write_b128 v43, v[212:215] offset:1024
    ds_write_b128 v43, v[216:219] offset:2048
    ds_write_b128 v43, v[220:223] offset:3072
    s_waitcnt lgkmcnt(0)
    s_mov_b64 exec, 1
    ds_add_rtn_u32 v46, v44, v45
    s_mov_b64 exec, -1
    s_add_u32 s83, s81, 32768
    buffer_load_dwordx4 v[80:83], v1, s[4:7], s83 offen offset:0 nt
    buffer_load_dwordx4 v[84:87], v1, s[4:7], s83 offen offset:1024 nt
    buffer_load_dwordx4 v[88:91], v1, s[4:7], s83 offen offset:2048 nt
    buffer_load_dwordx4 v[92:95], v1, s[4:7], s83 offen offset:3072 nt
    s_waitcnt lgkmcnt(0)
    v_readfirstlane_b32 s86, v46
    s_cmp_lg_u32 s86, 3
    s_cbranch_scc1 L_stream_8
    ds_read_b128 v[192:195], v42 offset:0
    ds_read_b128 v[196:199], v42 offset:1024
    ds_read_b128 v[200:203], v42 offset:2048
    ds_read_b128 v[204:207], v42 offset:3072
    ds_read_b128 v[208:211], v42 offset:16384
    ds_read_b128 v[212:215], v42 offset:17408
    ds_read_b128 v[216:219], v42 offset:18432
    ds_read_b128 v[220:223], v42 offset:19456
    ds_read_b128 v[224:227], v42 offset:32768
    ds_read_b128 v[228:231], v42 offset:33792
    ds_read_b128 v[232:235], v42 offset:34816
    ds_read_b128 v[236:239], v42 offset:35840
    s_waitcnt lgkmcnt(4)
    v_add_f32 v192, v192, v208
    v_add_f32 v193, v193, v209
    v_add_f32 v194, v194, v210
    v_add_f32 v195, v195, v211
    v_add_f32 v196, v196, v212
    v_add_f32 v197, v197, v213
    v_add_f32 v198, v198, v214
    v_add_f32 v199, v199, v215
    v_add_f32 v200, v200, v216
    v_add_f32 v201, v201, v217
    v_add_f32 v202, v202, v218
    v_add_f32 v203, v203, v219
    v_add_f32 v204, v204, v220
    v_add_f32 v205, v205, v221
    v_add_f32 v206, v206, v222
    v_add_f32 v207, v207, v223
    ds_read_b128 v[240:243], v42 offset:49152
    ds_read_b128 v[244:247], v42 offset:50176
    ds_read_b128 v[248:251], v42 offset:51200
    ds_read_b128 v[252:255], v42 offset:52224
    s_mov_b32 s88, 0xffff0000
    s_mov_b32 s87, 1069066811
    s_waitcnt lgkmcnt(0)
    v_add_f32 v224, v224, v240
    v_add_f32 v225, v225, v241
    v_add_f32 v226, v226, v242
    v_add_f32 v227, v227, v243
    v_add_f32 v228, v228, v244
    v_add_f32 v229, v229, v245
    v_add_f32 v230, v230, v246
    v_add_f32 v231, v231, v247
    v_add_f32 v232, v232, v248
    v_add_f32 v233, v233, v249
    v_add_f32 v234, v234, v250
    v_add_f32 v235, v235, v251
    v_add_f32 v236, v236, v252
    v_add_f32 v237, v237, v253
    v_add_f32 v238, v238, v254
    v_add_f32 v239, v239, v255
    v_add_f32 v192, v192, v224
    v_add_f32 v193, v193, v225
    v_add_f32 v194, v194, v226
    v_add_f32 v195, v195, v227
    v_add_f32 v196, v196, v228
    v_add_f32 v197, v197, v229
    v_add_f32 v198, v198, v230
    v_add_f32 v199, v199, v231
    v_add_f32 v200, v200, v232
    v_add_f32 v201, v201, v233
    v_add_f32 v202, v202, v234
    v_add_f32 v203, v203, v235
    v_add_f32 v204, v204, v236
    v_add_f32 v205, v205, v237
    v_add_f32 v206, v206, v238
    v_add_f32 v207, v207, v239
    v_mov_b32 v210, s70
    v_mov_b32 v211, s71
    v_cvt_pk_bf16_f32 v208, v192, v193
    v_cvt_pk_bf16_f32 v209, v194, v195
    v_mov_b32 v214, s70
    v_mov_b32 v215, s71
    v_cvt_pk_bf16_f32 v212, v196, v197
    v_cvt_pk_bf16_f32 v213, v198, v199
    v_mov_b32 v218, s70
    v_mov_b32 v219, s71
    v_cvt_pk_bf16_f32 v216, v200, v201
    v_cvt_pk_bf16_f32 v217, v202, v203
    v_mov_b32 v222, s70
    v_mov_b32 v223, s71
    v_cvt_pk_bf16_f32 v220, v204, v205
    v_cvt_pk_bf16_f32 v221, v206, v207
    v_mov_b32 v44, 147456
    s_cmp_eq_u32 s91, 1
    s_cbranch_scc1 L_prod_gfin
    v_lshlrev_b32 v46, 14, v63
    v_lshl_add_u32 v46, v52, 4, v46
    s_lshl_b32 s86, s43, 8
    s_mov_b64 exec, s[60:61]
    buffer_store_dwordx4 v[208:211], v46, s[12:15], s86 offen offset:0 sc1
    buffer_store_dwordx4 v[212:215], v46, s[12:15], s86 offen offset:64 sc1
    buffer_store_dwordx4 v[216:219], v46, s[12:15], s86 offen offset:128 sc1
    buffer_store_dwordx4 v[220:223], v46, s[12:15], s86 offen offset:192 sc1
    s_mov_b64 exec, 1
    ds_add_u32 v44, v45
    s_mov_b64 exec, -1
    s_branch L_stream_8
L_prod_gfin:
    v_lshlrev_b32 v224, 16, v208
    v_and_b32 v225, s88, v208
    v_lshlrev_b32 v232, 16, v216
    v_and_b32 v233, s88, v216
    v_lshlrev_b32 v226, 16, v209
    v_and_b32 v227, s88, v209
    v_lshlrev_b32 v234, 16, v217
    v_and_b32 v235, s88, v217
    v_lshlrev_b32 v228, 16, v212
    v_and_b32 v229, s88, v212
    v_lshlrev_b32 v236, 16, v220
    v_and_b32 v237, s88, v220
    v_lshlrev_b32 v230, 16, v213
    v_and_b32 v231, s88, v213
    v_lshlrev_b32 v238, 16, v221
    v_and_b32 v239, s88, v221
    v_mul_f32 v224, s87, v224
    v_sub_f32 v224, 0, v224
    v_exp_f32 v224, v224
    v_mul_f32 v225, s87, v225
    v_sub_f32 v225, 0, v225
    v_exp_f32 v225, v225
    v_mul_f32 v226, s87, v226
    v_sub_f32 v226, 0, v226
    v_exp_f32 v226, v226
    v_mul_f32 v227, s87, v227
    v_sub_f32 v227, 0, v227
    v_exp_f32 v227, v227
    v_mul_f32 v228, s87, v228
    v_sub_f32 v228, 0, v228
    v_exp_f32 v228, v228
    v_mul_f32 v229, s87, v229
    v_sub_f32 v229, 0, v229
    v_exp_f32 v229, v229
    v_mul_f32 v230, s87, v230
    v_sub_f32 v230, 0, v230
    v_exp_f32 v230, v230
    v_mul_f32 v231, s87, v231
    v_sub_f32 v231, 0, v231
    v_exp_f32 v231, v231
    v_add_f32 v224, 1.0, v224
    v_add_f32 v225, 1.0, v225
    v_add_f32 v226, 1.0, v226
    v_add_f32 v227, 1.0, v227
    v_add_f32 v228, 1.0, v228
    v_add_f32 v229, 1.0, v229
    v_add_f32 v230, 1.0, v230
    v_add_f32 v231, 1.0, v231
    v_rcp_f32 v224, v224
    v_rcp_f32 v225, v225
    v_rcp_f32 v226, v226
    v_rcp_f32 v227, v227
    v_rcp_f32 v228, v228
    v_rcp_f32 v229, v229
    v_rcp_f32 v230, v230
    v_rcp_f32 v231, v231
    s_nop 0
    v_cvt_pk_bf16_f32 v240, v224, v225
    v_lshlrev_b32 v224, 16, v240
    v_and_b32 v225, s88, v240
    v_cvt_pk_bf16_f32 v241, v226, v227
    v_lshlrev_b32 v226, 16, v241
    v_and_b32 v227, s88, v241
    v_cvt_pk_bf16_f32 v242, v228, v229
    v_lshlrev_b32 v228, 16, v242
    v_and_b32 v229, s88, v242
    v_cvt_pk_bf16_f32 v243, v230, v231
    v_lshlrev_b32 v230, 16, v243
    v_and_b32 v231, s88, v243
    v_mul_f32 v224, v224, v232
    v_mul_f32 v225, v225, v233
    v_mul_f32 v226, v226, v234
    v_mul_f32 v227, v227, v235
    v_mul_f32 v228, v228, v236
    v_mul_f32 v229, v229, v237
    v_mul_f32 v230, v230, v238
    v_mul_f32 v231, v231, v239
    v_cvt_pk_bf16_f32 v208, v224, v225
    v_cvt_pk_bf16_f32 v209, v226, v227
    v_cvt_pk_bf16_f32 v212, v228, v229
    v_cvt_pk_bf16_f32 v213, v230, v231
    v_mul_u32_u24 v46, 7168, v63
    v_lshl_add_u32 v46, v52, 4, v46
    s_lshl_b32 s86, s42, 7
    s_add_u32 s86, s86, 131072
    s_mov_b64 exec, s[60:61]
    buffer_store_dwordx4 v[208:211], v46, s[12:15], s86 offen offset:0 sc1
    buffer_store_dwordx4 v[212:215], v46, s[12:15], s86 offen offset:64 sc1
    s_mov_b64 exec, 1
    ds_add_u32 v44, v45
    s_mov_b64 exec, -1
    s_branch L_stream_8
L_role0:
    v_lshlrev_b32 v43, 9, v50
    v_lshrrev_b32 v44, 2, v0
    v_lshl_add_u32 v43, v44, 5, v43
    s_bfe_u32 s86, s79, 0x30002
    s_lshr_b32 s93, s79, 5
    s_lshl_b32 s93, s93, 14
    s_lshl_b32 s86, s86, 11
    s_add_u32 s93, s93, s86
    v_lshlrev_b32 v41, 4, v0
    v_add_u32 v41, 148480, v41
    v_mov_b32 v42, 147456
    v_mov_b32 v36, 1
    s_mov_b32 s85, 200000
    s_mov_b64 s[66:67], -1
    s_mov_b64 s[64:65], -1
    s_waitcnt vmcnt(3)
    s_add_u32 s83, s81, 32768
    buffer_load_dwordx4 v[80:83], v1, s[4:7], s83 offen offset:0 nt
    s_waitcnt vmcnt(3)
    buffer_load_dwordx4 v[84:87], v1, s[4:7], s83 offen offset:1024 nt
    s_waitcnt vmcnt(3)
    buffer_load_dwordx4 v[88:91], v1, s[4:7], s83 offen offset:2048 nt
    s_waitcnt vmcnt(3)
    buffer_load_dwordx4 v[92:95], v1, s[4:7], s83 offen offset:3072 nt
    s_mov_b32 s69, 8
    s_waitcnt vmcnt(3)
    s_add_u32 s83, s81, 65536
    buffer_load_dwordx4 v[96:99], v1, s[4:7], s83 offen offset:0 nt
    s_waitcnt vmcnt(3)
    buffer_load_dwordx4 v[100:103], v1, s[4:7], s83 offen offset:1024 nt
    s_waitcnt vmcnt(3)
    buffer_load_dwordx4 v[104:107], v1, s[4:7], s83 offen offset:2048 nt
    s_waitcnt vmcnt(3)
    buffer_load_dwordx4 v[108:111], v1, s[4:7], s83 offen offset:3072 nt
    s_mov_b32 s69, 12
    s_waitcnt vmcnt(3)
    s_add_u32 s83, s81, 98304
    buffer_load_dwordx4 v[112:115], v1, s[4:7], s83 offen offset:0 nt
    s_waitcnt vmcnt(3)
    buffer_load_dwordx4 v[116:119], v1, s[4:7], s83 offen offset:1024 nt
    s_waitcnt vmcnt(3)
    buffer_load_dwordx4 v[120:123], v1, s[4:7], s83 offen offset:2048 nt
    s_waitcnt vmcnt(3)
    buffer_load_dwordx4 v[124:127], v1, s[4:7], s83 offen offset:3072 nt
    s_mov_b32 s69, 16
    s_waitcnt vmcnt(3)
    s_add_u32 s83, s81, 131072
    buffer_load_dwordx4 v[128:131], v1, s[4:7], s83 offen offset:0 nt
    s_waitcnt vmcnt(3)
    buffer_load_dwordx4 v[132:135], v1, s[4:7], s83 offen offset:1024 nt
    s_waitcnt vmcnt(3)
    buffer_load_dwordx4 v[136:139], v1, s[4:7], s83 offen offset:2048 nt
    s_waitcnt vmcnt(3)
    buffer_load_dwordx4 v[140:143], v1, s[4:7], s83 offen offset:3072 nt
    s_mov_b32 s69, 20
    s_or_b64 exec, s[66:67], 1
    buffer_load_dwordx4 v[44:47], v43, s[12:15], s93 offen sc1
    s_or_b64 exec, s[64:65], 1
    buffer_load_dwordx4 v[24:27], v43, s[12:15], s93 offen offset:16 sc1
    s_mov_b64 exec, -1
    s_waitcnt vmcnt(5)
    s_add_u32 s83, s81, 163840
    buffer_load_dwordx4 v[144:147], v1, s[4:7], s83 offen offset:0 nt
    s_waitcnt vmcnt(5)
    buffer_load_dwordx4 v[148:151], v1, s[4:7], s83 offen offset:1024 nt
    s_waitcnt vmcnt(5)
    buffer_load_dwordx4 v[152:155], v1, s[4:7], s83 offen offset:2048 nt
    s_waitcnt vmcnt(5)
    buffer_load_dwordx4 v[156:159], v1, s[4:7], s83 offen offset:3072 nt
    s_mov_b32 s69, 24
    s_waitcnt vmcnt(4)
    v_cmp_ne_u64 s[66:67], s[70:71], v[46:47]
    v_cmp_ne_u64 s[64:65], s[70:71], v[26:27]
    s_nop 0
    s_or_b64 s[86:87], s[66:67], s[64:65]
    s_cbranch_scc0 L_pq_ok
    s_or_b64 exec, s[66:67], 1
    buffer_load_dwordx4 v[44:47], v43, s[12:15], s93 offen sc1
    s_or_b64 exec, s[64:65], 1
    buffer_load_dwordx4 v[24:27], v43, s[12:15], s93 offen offset:16 sc1
    s_mov_b64 exec, -1
    s_waitcnt vmcnt(5)
    s_add_u32 s83, s81, 196608
    buffer_load_dwordx4 v[160:163], v1, s[4:7], s83 offen offset:0 nt
    s_waitcnt vmcnt(5)
    buffer_load_dwordx4 v[164:167], v1, s[4:7], s83 offen offset:1024 nt
    s_waitcnt vmcnt(5)
    buffer_load_dwordx4 v[168:171], v1, s[4:7], s83 offen offset:2048 nt
    s_waitcnt vmcnt(5)
    buffer_load_dwordx4 v[172:175], v1, s[4:7], s83 offen offset:3072 nt
    s_mov_b32 s69, 28
    s_waitcnt vmcnt(4)
    v_cmp_ne_u64 s[66:67], s[70:71], v[46:47]
    v_cmp_ne_u64 s[64:65], s[70:71], v[26:27]
    s_nop 0
    s_or_b64 s[86:87], s[66:67], s[64:65]
    s_cbranch_scc0 L_pq_ok
    s_or_b64 exec, s[66:67], 1
    buffer_load_dwordx4 v[44:47], v43, s[12:15], s93 offen sc1
    s_or_b64 exec, s[64:65], 1
    buffer_load_dwordx4 v[24:27], v43, s[12:15], s93 offen offset:16 sc1
    s_mov_b64 exec, -1
    s_waitcnt vmcnt(5)
    s_add_u32 s83, s81, 229376
    buffer_load_dwordx4 v[176:179], v1, s[4:7], s83 offen offset:0 nt
    s_waitcnt vmcnt(5)
    buffer_load_dwordx4 v[180:183], v1, s[4:7], s83 offen offset:1024 nt
    s_waitcnt vmcnt(5)
    buffer_load_dwordx4 v[184:187], v1, s[4:7], s83 offen offset:2048 nt
    s_waitcnt vmcnt(5)
    buffer_load_dwordx4 v[188:191], v1, s[4:7], s83 offen offset:3072 nt
    s_mov_b32 s69, 32
    s_waitcnt vmcnt(4)
    v_cmp_ne_u64 s[66:67], s[70:71], v[46:47]
    v_cmp_ne_u64 s[64:65], s[70:71], v[26:27]
    s_nop 0
    s_or_b64 s[86:87], s[66:67], s[64:65]
    s_cbranch_scc0 L_pq_ok
L_pq:
    s_sub_u32 s85, s85, 1
    s_cmp_eq_u32 s85, 0
    s_cbranch_scc1 L_pq_ok
    s_sleep 1
    s_or_b64 exec, s[66:67], 1
    buffer_load_dwordx4 v[44:47], v43, s[12:15], s93 offen sc1
    s_or_b64 exec, s[64:65], 1
    buffer_load_dwordx4 v[24:27], v43, s[12:15], s93 offen offset:16 sc1
    s_mov_b64 exec, -1
    s_waitcnt vmcnt(0)
    v_cmp_ne_u64 s[66:67], s[70:71], v[46:47]
    v_cmp_ne_u64 s[64:65], s[70:71], v[26:27]
    s_nop 0
    s_or_b64 s[86:87], s[66:67], s[64:65]
    s_cbranch_scc0 L_pq_ok
    s_branch L_pq
L_pq_ok:
    v_mov_b32 v46, v24
    v_mov_b32 v47, v25
    ds_write_b128 v41, v[44:47]
    s_waitcnt lgkmcnt(0)
    s_mov_b64 exec, 1
    ds_add_u32 v42, v36
    s_mov_b64 exec, -1
    s_cmp_eq_u32 s69, 8
    s_cbranch_scc1 L_stream_8
    s_cmp_eq_u32 s69, 12
    s_cbranch_scc1 L_stream_12
    s_cmp_eq_u32 s69, 16
    s_cbranch_scc1 L_stream_16
    s_cmp_eq_u32 s69, 20
    s_cbranch_scc1 L_stream_20
    s_cmp_eq_u32 s69, 24
    s_cbranch_scc1 L_stream_24
    s_cmp_eq_u32 s69, 28
    s_cbranch_scc1 L_stream_28
    s_branch L_stream_32

L_role2:
    s_mov_b32 s64, s32
    s_and_b32 s65, s33, 0xffff
    s_mov_b32 s66, 1835008
    s_mov_b32 s67, 0x20000
    v_lshl_add_u32 v61, v58, 10, v59
    s_mul_i32 s86, s90, 57344
    s_lshl_b32 s93, s89, 7
    s_add_u32 s86, s86, s93
    s_mov_b32 m0, 155648
    s_nop 0
    buffer_load_dwordx4 v61, s[64:67], s86 offen nt lds
    s_mov_b32 m0, 156672
    s_add_u32 s86, s86, 8192
    buffer_load_dwordx4 v61, s[64:67], s86 offen nt lds
    s_mov_b32 m0, 157696
    s_add_u32 s86, s86, 8192
    buffer_load_dwordx4 v61, s[64:67], s86 offen nt lds
    s_mov_b32 m0, 158720
    s_add_u32 s86, s86, 8192
    buffer_load_dwordx4 v61, s[64:67], s86 offen nt lds
    s_mov_b32 m0, 159744
    s_add_u32 s86, s86, 8192
    buffer_load_dwordx4 v61, s[64:67], s86 offen nt lds
    s_mov_b32 m0, 160768
    s_add_u32 s86, s86, 8192
    buffer_load_dwordx4 v61, s[64:67], s86 offen nt lds
    s_mov_b32 m0, 161792
    s_add_u32 s86, s86, 8192
    buffer_load_dwordx4 v61, s[64:67], s86 offen nt lds
    s_mov_b32 m0, 162816
    s_add_u32 s86, s86, 8192
    buffer_load_dwordx4 v61, s[64:67], s86 offen nt lds
    s_branch L_stream_4
L_glu2_0:
    v_lshrrev_b32 v55, 4, v0
    v_and_b32 v52, 7, v0
    v_mul_u32_u24 v52, 7168, v52
    v_lshl_add_u32 v52, v55, 5, v52
    s_mul_i32 s64, s90, 224
    s_add_u32 s64, s64, 131072
    buffer_load_dwordx4 v[224:227], v52, s[12:15], s64 offen offset:0 sc1
    buffer_load_dwordx4 v[228:231], v52, s[12:15], s64 offen offset:16 sc1
    buffer_load_dwordx4 v[232:235], v52, s[12:15], s64 offen offset:128 sc1
    buffer_load_dwordx4 v[236:239], v52, s[12:15], s64 offen offset:144 sc1
    s_branch L_glu2_ret0
L_glu2_1:
    v_lshrrev_b32 v55, 4, v0
    v_and_b32 v52, 7, v0
    v_mul_u32_u24 v52, 7168, v52
    v_lshl_add_u32 v52, v55, 5, v52
    s_mul_i32 s64, s90, 224
    s_add_u32 s64, s64, 131072
    s_mov_b32 s85, 200000
    s_mov_b32 s66, -1
    s_mov_b32 s67, 0x0000ffff
    s_waitcnt vmcnt(8)
L_ph:
    v_cmp_ne_u64 s[86:87], s[70:71], v[226:227]
    v_cmp_ne_u64 s[92:93], s[70:71], v[230:231]
    s_or_b64 s[86:87], s[86:87], s[92:93]
    v_cmp_ne_u64 s[92:93], s[70:71], v[234:235]
    v_cmp_ne_u64 s[56:57], s[70:71], v[238:239]
    s_or_b64 s[92:93], s[92:93], s[56:57]
    s_and_b64 s[92:93], s[92:93], s[66:67]
    s_or_b64 s[86:87], s[86:87], s[92:93]
    s_cbranch_scc0 L_ph_ok
    s_sub_u32 s85, s85, 1
    s_cmp_eq_u32 s85, 0
    s_cbranch_scc1 L_ph_ok
    s_sleep 30
    buffer_load_dwordx4 v[224:227], v52, s[12:15], s64 offen offset:0 sc1
    buffer_load_dwordx4 v[228:231], v52, s[12:15], s64 offen offset:16 sc1
    buffer_load_dwordx4 v[232:235], v52, s[12:15], s64 offen offset:128 sc1
    buffer_load_dwordx4 v[236:239], v52, s[12:15], s64 offen offset:144 sc1
    s_waitcnt vmcnt(0)
    s_branch L_ph
L_ph_ok:
    v_mov_b32 v226, v228
    v_mov_b32 v227, v229
    v_mov_b32 v234, v236
    v_mov_b32 v235, v237
    v_cndmask_b32 v228, 0, v232, s[66:67]
    v_cndmask_b32 v229, 0, v233, s[66:67]
    v_cndmask_b32 v230, 0, v234, s[66:67]
    v_cndmask_b32 v231, 0, v235, s[66:67]
    v_add_u32 v54, 155648, v62
    v_lshlrev_b32 v53, 4, v0
    v_add_u32 v53, 155648, v53
    ds_read_b64_tr_b16 v[176:177], v54 offset:0
    ds_read_b64_tr_b16 v[178:179], v54 offset:512
    ds_read_b64_tr_b16 v[180:181], v54 offset:32
    ds_read_b64_tr_b16 v[182:183], v54 offset:544
    ds_read_b64_tr_b16 v[184:185], v54 offset:64
    ds_read_b64_tr_b16 v[186:187], v54 offset:576
    ds_read_b64_tr_b16 v[188:189], v54 offset:96
    ds_read_b64_tr_b16 v[190:191], v54 offset:608
    s_waitcnt lgkmcnt(6)
    v_mfma_f32_16x16x32_bf16 v[160:163], v[176:179], v[224:227], 0
    s_waitcnt lgkmcnt(4)
    v_mfma_f32_16x16x32_bf16 v[164:167], v[180:183], v[224:227], 0
    s_waitcnt lgkmcnt(2)
    v_mfma_f32_16x16x32_bf16 v[168:171], v[184:187], v[224:227], 0
    s_waitcnt lgkmcnt(0)
    v_mfma_f32_16x16x32_bf16 v[172:175], v[188:191], v[224:227], 0
    ds_read_b64_tr_b16 v[192:193], v54 offset:4096
    ds_read_b64_tr_b16 v[194:195], v54 offset:4608
    ds_read_b64_tr_b16 v[196:197], v54 offset:4128
    ds_read_b64_tr_b16 v[198:199], v54 offset:4640
    ds_read_b64_tr_b16 v[200:201], v54 offset:4160
    ds_read_b64_tr_b16 v[202:203], v54 offset:4672
    ds_read_b64_tr_b16 v[204:205], v54 offset:4192
    ds_read_b64_tr_b16 v[206:207], v54 offset:4704
    s_waitcnt lgkmcnt(6)
    v_mfma_f32_16x16x32_bf16 v[160:163], v[192:195], v[228:231], v[160:163]
    s_waitcnt lgkmcnt(4)
    v_mfma_f32_16x16x32_bf16 v[164:167], v[196:199], v[228:231], v[164:167]
    s_waitcnt lgkmcnt(2)
    v_mfma_f32_16x16x32_bf16 v[168:171], v[200:203], v[228:231], v[168:171]
    s_waitcnt lgkmcnt(0)
    v_mfma_f32_16x16x32_bf16 v[172:175], v[204:207], v[228:231], v[172:175]
    s_nop 4
    ds_write_b128 v53, v[160:163] offset:0
    ds_write_b128 v53, v[164:167] offset:1024
    ds_write_b128 v53, v[168:171] offset:2048
    ds_write_b128 v53, v[172:175] offset:3072
    s_branch L_glu2_ret1
L_role3:
    s_mov_b32 s64, s24
    s_and_b32 s65, s25, 0xffff
    s_mov_b32 s66, 4194304
    s_mov_b32 s67, 0x20000
    v_lshl_add_u32 v61, v58, 10, v59
    s_lshl_b32 s86, s90, 17
    s_lshl_b32 s93, s89, 7
    s_add_u32 s86, s86, s93
    s_mov_b32 m0, 131072
    s_nop 0
    buffer_load_dwordx4 v61, s[64:67], s86 offen nt lds
    s_mov_b32 m0, 132096
    s_add_u32 s86, s86, 8192
    buffer_load_dwordx4 v61, s[64:67], s86 offen nt lds
    s_mov_b32 m0, 133120
    s_add_u32 s86, s86, 8192
    buffer_load_dwordx4 v61, s[64:67], s86 offen nt lds
    s_mov_b32 m0, 134144
    s_add_u32 s86, s86, 8192
    buffer_load_dwordx4 v61, s[64:67], s86 offen nt lds
    s_mov_b32 m0, 135168
    s_add_u32 s86, s86, 8192
    buffer_load_dwordx4 v61, s[64:67], s86 offen nt lds
    s_mov_b32 m0, 136192
    s_add_u32 s86, s86, 8192
    buffer_load_dwordx4 v61, s[64:67], s86 offen nt lds
    s_mov_b32 m0, 137216
    s_add_u32 s86, s86, 8192
    buffer_load_dwordx4 v61, s[64:67], s86 offen nt lds
    s_mov_b32 m0, 138240
    s_add_u32 s86, s86, 8192
    buffer_load_dwordx4 v61, s[64:67], s86 offen nt lds
    s_mov_b32 m0, 139264
    s_add_u32 s86, s86, 8192
    buffer_load_dwordx4 v61, s[64:67], s86 offen nt lds
    s_mov_b32 m0, 140288
    s_add_u32 s86, s86, 8192
    buffer_load_dwordx4 v61, s[64:67], s86 offen nt lds
    s_mov_b32 m0, 141312
    s_add_u32 s86, s86, 8192
    buffer_load_dwordx4 v61, s[64:67], s86 offen nt lds
    s_mov_b32 m0, 142336
    s_add_u32 s86, s86, 8192
    buffer_load_dwordx4 v61, s[64:67], s86 offen nt lds
    s_mov_b32 m0, 143360
    s_add_u32 s86, s86, 8192
    buffer_load_dwordx4 v61, s[64:67], s86 offen nt lds
    s_mov_b32 m0, 144384
    s_add_u32 s86, s86, 8192
    buffer_load_dwordx4 v61, s[64:67], s86 offen nt lds
    s_mov_b32 m0, 145408
    s_add_u32 s86, s86, 8192
    buffer_load_dwordx4 v61, s[64:67], s86 offen nt lds
    s_mov_b32 m0, 146432
    s_add_u32 s86, s86, 8192
    buffer_load_dwordx4 v61, s[64:67], s86 offen nt lds
    s_mov_b32 s64, s16
    s_and_b32 s65, s17, 0xffff
    s_mov_b32 s66, 8192
    s_mov_b32 s67, 0x20000
    s_mov_b32 s52, s34
    s_and_b32 s53, s35, 0xffff
    s_mov_b32 s54, 1024
    s_mov_b32 s55, 0x20000
    v_lshlrev_b32 v61, 4, v0
    s_lshr_b32 s86, s2, 5
    s_lshl_b32 s86, s86, 10
    buffer_load_dwordx4 v[240:243], v61, s[64:67], s86 offen
    buffer_load_dwordx4 v[244:247], v61, s[52:55], 0 offen
    s_branch L_stream_4
L_gate:
    s_mov_b32 s88, 0xffff0000
    s_mov_b32 s87, 1069066811
    v_lshlrev_b32 v224, 16, v240
    v_and_b32 v225, s88, v240
    v_lshlrev_b32 v232, 16, v244
    v_and_b32 v233, s88, v244
    v_lshlrev_b32 v226, 16, v241
    v_and_b32 v227, s88, v241
    v_lshlrev_b32 v234, 16, v245
    v_and_b32 v235, s88, v245
    v_lshlrev_b32 v228, 16, v242
    v_and_b32 v229, s88, v242
    v_lshlrev_b32 v236, 16, v246
    v_and_b32 v237, s88, v246
    v_lshlrev_b32 v230, 16, v243
    v_and_b32 v231, s88, v243
    v_lshlrev_b32 v238, 16, v247
    v_and_b32 v239, s88, v247
    v_mul_f32 v224, v224, v232
    v_mul_f32 v225, v225, v233
    v_mul_f32 v226, v226, v234
    v_mul_f32 v227, v227, v235
    v_mul_f32 v228, v228, v236
    v_mul_f32 v229, v229, v237
    v_mul_f32 v230, v230, v238
    v_mul_f32 v231, v231, v239
    v_cvt_pk_bf16_f32 v232, v224, v225
    v_lshlrev_b32 v224, 16, v232
    v_and_b32 v225, s88, v232
    v_cvt_pk_bf16_f32 v233, v226, v227
    v_lshlrev_b32 v226, 16, v233
    v_and_b32 v227, s88, v233
    v_cvt_pk_bf16_f32 v234, v228, v229
    v_lshlrev_b32 v228, 16, v234
    v_and_b32 v229, s88, v234
    v_cvt_pk_bf16_f32 v235, v230, v231
    v_lshlrev_b32 v230, 16, v235
    v_and_b32 v231, s88, v235
    v_add_f32 v224, v224, v225
    v_add_f32 v224, v224, v226
    v_add_f32 v224, v224, v227
    v_add_f32 v224, v224, v228
    v_add_f32 v224, v224, v229
    v_add_f32 v224, v224, v230
    v_add_f32 v224, v224, v231
    s_nop 1
    v_add_f32_dpp v224, v224, v224 quad_perm:[1,0,3,2] row_mask:0xf bank_mask:0xf
    s_nop 1
    v_add_f32_dpp v224, v224, v224 quad_perm:[2,3,0,1] row_mask:0xf bank_mask:0xf
    s_nop 1
    v_add_f32_dpp v224, v224, v224 row_ror:4 row_mask:0xf bank_mask:0xf
    s_nop 1
    v_add_f32_dpp v224, v224, v224 row_ror:8 row_mask:0xf bank_mask:0xf
    v_mov_b32 v225, v224
    s_nop 1
    v_permlane16_swap_b32 v224, v225
    v_add_f32 v224, v224, v225
    v_mov_b32 v225, v224
    s_nop 1
    v_permlane32_swap_b32 v224, v225
    v_add_f32 v224, v224, v225
    v_cvt_pk_bf16_f32 v224, v224, v224
    v_and_b32 v224, s88, v224
    v_mul_f32 v224, s87, v224
    v_sub_f32 v224, 0, v224
    v_exp_f32 v224, v224
    s_nop 0
    v_add_f32 v224, 1.0, v224
    v_rcp_f32 v224, v224
    s_nop 0
    v_cvt_pk_bf16_f32 v224, v224, v224
    v_and_b32 v224, s88, v224
    v_mov_b32 v225, 147472
    ds_write_b32 v225, v224
    s_branch L_gate_ret
L_bal_0:
    s_memrealtime s[64:65]
    s_lshl_b32 s66, s79, 4
    s_add_u32 s66, s66, 245760
    v_mov_b32 v51, 0
    v_mov_b32 v54, s70
    v_mov_b32 v55, s71
    s_waitcnt lgkmcnt(0)
    s_sub_u32 s64, s64, s74
    v_mov_b32 v52, s64
    v_mov_b32 v53, s64
    s_mov_b64 exec, 1
    buffer_store_dwordx4 v[52:55], v51, s[12:15], s66 offen sc1
    s_mov_b64 exec, -1
    s_branch L_bal_ret0
L_bal_1:
    s_and_b32 s66, s79, 0xfc
    s_lshl_b32 s66, s66, 4
    s_add_u32 s66, s66, 245760
    v_and_b32 v51, 3, v0
    v_lshlrev_b32 v51, 4, v51
    buffer_load_dwordx4 v[52:55], v51, s[12:15], s66 offen sc1
    s_branch L_bal_ret1
L_bal_2:
    v_and_b32 v51, 3, v0
    v_lshlrev_b32 v51, 4, v51
    s_mov_b32 s85, 200000
    s_waitcnt vmcnt(4)
L_bal_chk:
    v_cmp_ne_u64 s[86:87], s[70:71], v[54:55]
    s_sub_u32 s85, s85, 1
    s_cmp_eq_u32 s85, 0
    s_cbranch_scc1 L_bal_ok
    s_cmp_eq_u64 s[86:87], 0
    s_cbranch_scc1 L_bal_ok
    s_sleep 4
    buffer_load_dwordx4 v[52:55], v51, s[12:15], s66 offen sc1
    s_waitcnt vmcnt(0)
    s_branch L_bal_chk
L_bal_ok:
    v_cvt_f32_u32 v52, v52
    s_nop 1
    v_add_f32_dpp v53, v52, v52 quad_perm:[1,0,3,2] row_mask:0xf bank_mask:0xf
    s_nop 1
    v_add_f32_dpp v53, v53, v53 quad_perm:[2,3,0,1] row_mask:0xf bank_mask:0xf
    v_rcp_f32 v53, v53
    s_nop 0
    v_mul_f32 v52, v52, v53
    v_mul_f32 v52, 0xc37acccd, v52
    v_add_f32 v52, 0x428d6666, v52
    v_mov_b32 v57, 0x41800000
    v_med3_f32 v52, v52, 0, v57
    s_nop 1
    v_add_f32_dpp v53, v52, v52 quad_perm:[1,0,3,2] row_mask:0xf bank_mask:0xf
    s_nop 1
    v_add_f32_dpp v53, v53, v53 quad_perm:[2,3,0,1] row_mask:0xf bank_mask:0xf
    v_sub_f32 v53, 0x42000000, v53
    v_cmp_lt_f32 s[86:87], 0, v53
    v_sub_f32 v54, v57, v52
    s_nop 0
    v_cndmask_b32 v54, v52, v54, s[86:87]
    v_cmp_lt_f32 s[86:87], 0, v54
    s_nop 1
    v_cndmask_b32 v54, 0, 1.0, s[86:87]
    s_nop 1
    v_add_f32_dpp v55, v54, v54 quad_perm:[1,0,3,2] row_mask:0xf bank_mask:0xf
    s_nop 1
    v_add_f32_dpp v55, v55, v55 quad_perm:[2,3,0,1] row_mask:0xf bank_mask:0xf
    v_max_f32 v55, 1.0, v55
    v_rcp_f32 v55, v55
    v_mul_f32 v53, v53, v54
    v_fmac_f32 v52, v53, v55
    v_med3_f32 v52, v52, 0, v57
    s_nop 1
    v_add_f32_dpp v53, v52, v52 quad_perm:[1,0,3,2] row_mask:0xf bank_mask:0xf
    s_nop 1
    v_add_f32_dpp v53, v53, v53 quad_perm:[2,3,0,1] row_mask:0xf bank_mask:0xf
    v_sub_f32 v53, 0x42000000, v53
    v_cmp_lt_f32 s[86:87], 0, v53
    v_sub_f32 v54, v57, v52
    s_nop 0
    v_cndmask_b32 v54, v52, v54, s[86:87]
    v_cmp_lt_f32 s[86:87], 0, v54
    s_nop 1
    v_cndmask_b32 v54, 0, 1.0, s[86:87]
    s_nop 1
    v_add_f32_dpp v55, v54, v54 quad_perm:[1,0,3,2] row_mask:0xf bank_mask:0xf
    s_nop 1
    v_add_f32_dpp v55, v55, v55 quad_perm:[2,3,0,1] row_mask:0xf bank_mask:0xf
    v_max_f32 v55, 1.0, v55
    v_rcp_f32 v55, v55
    v_mul_f32 v53, v53, v54
    v_fmac_f32 v52, v53, v55
    v_mov_b32 v53, 0
    v_mov_b32 v54, 0
    s_nop 0
    v_mov_b32_dpp v53, v52 quad_perm:[0,0,1,2] row_mask:0xf bank_mask:0xf
    v_mov_b32_dpp v54, v52 quad_perm:[0,0,0,1] row_mask:0xf bank_mask:0xf
    v_add_f32 v55, 0.5, v52
    v_add_f32 v56, v55, v53
    v_add_f32 v57, v56, v54
    v_floor_f32 v55, v55
    v_floor_f32 v56, v56
    v_floor_f32 v57, v57
    v_cvt_i32_f32 v55, v55
    v_cvt_i32_f32 v56, v56
    v_cvt_i32_f32 v57, v57
    s_nop 0
    v_readlane_b32 s64, v55, 0
    v_readlane_b32 s65, v56, 1
    v_readlane_b32 s66, v57, 2
    s_nop 1
    s_max_i32 s64, s64, 0
    s_min_i32 s64, s64, 16
    s_max_i32 s65, s65, s64
    s_add_i32 s67, s64, 16
    s_min_i32 s65, s65, s67
    s_max_i32 s66, s66, s65
    s_max_i32 s66, s66, 16
    s_add_i32 s67, s65, 16
    s_min_i32 s66, s66, s67
    s_min_i32 s66, s66, 32
    s_and_b32 s67, s79, 3
    s_mov_b32 s86, 0
    s_mov_b32 s87, s64
    s_cmp_eq_u32 s67, 1
    s_cselect_b32 s86, s64, s86
    s_cselect_b32 s87, s65, s87
    s_cmp_eq_u32 s67, 2
    s_cselect_b32 s86, s65, s86
    s_cselect_b32 s87, s66, s87
    s_cmp_eq_u32 s67, 3
    s_cselect_b32 s86, s66, s86
    s_cselect_b32 s87, 32, s87
    s_sub_u32 s87, s87, s86
    s_lshl_b32 s87, s87, 1
    s_lshl_b32 s86, s86, 1
    v_mov_b32 v52, 1
    v_mov_b32 v54, s87
    v_mov_b32 v55, s86
    v_mov_b32 v50, 147488
    ds_write_b64 v50, v[54:55] offset:8
    ds_write_b32 v50, v52
    s_branch L_bal_ret2
L_done:
    s_endpgm
.section .rodata,"a"
.p2align 6
.amdhsa_kernel gated_mix__gqa_block_cached__glu_gated_glu__decode_kernel
  .amdhsa_next_free_vgpr 256
  .amdhsa_next_free_sgpr 102
  .amdhsa_accum_offset 256
  .amdhsa_group_segment_fixed_size 0
  .amdhsa_kernarg_size 104
  .amdhsa_user_sgpr_count 2
  .amdhsa_user_sgpr_kernarg_segment_ptr 1
  .amdhsa_system_sgpr_workgroup_id_x 1
.end_amdhsa_kernel
```
